```python
import torch

def _softmax(x, axis=-1):
    return torch.softmax(x, dim=axis)
def _gelu(x):
    return torch.nn.functional.gelu(x, approximate="tanh")
def _silu(x):
    return torch.nn.functional.silu(x)
def _sigmoid(x):
    return torch.sigmoid(x)
def _layernorm(x, axis=-1, eps=1e-5):
    m = x.mean(dim=axis, keepdim=True)
    v = x.var(dim=axis, keepdim=True, unbiased=False)
    return (x - m) / torch.sqrt(v + eps)
def _scatter_add(tgt, idx, src, axis=0):
    return tgt.clone().index_add_(axis, idx, src)
def _segment_sum(src, seg, n):
    out = torch.zeros((n,) + src.shape[1:], dtype=src.dtype)
    return out.index_add_(0, seg, src)
def _pad(x, pw):
    flat = tuple(v for pair in reversed(pw) for v in pair)
    return torch.nn.functional.pad(x, flat)

kernel_name = 'gated_mix__ssm_conv_s5__glu_gated_swiglu__prompt'

def setup_inputs():

    _w = (lambda a: (lambda t: t.to(torch.bfloat16) if t.is_floating_point() else t)(torch.as_tensor(a)))
    def _A_setup():
        B, S, D = 1, 2048, 512
        P = D
        Lambda_re = -0.5 * (lambda _x: torch.exp(torch.as_tensor(_x)))((lambda *s: torch.randn(*s, dtype=torch.bfloat16) * 0.2)(P))
        Lambda_im = (lambda *s: torch.randn(*s, dtype=torch.bfloat16) * 0.4)(P) * 1.0
        B_re = (lambda *s: torch.randn(*s, dtype=torch.bfloat16) * 0.2)(P, D) * (D ** -0.5)
        B_im = (lambda *s: torch.randn(*s, dtype=torch.bfloat16) * 0.2)(P, D) * (D ** -0.5)
        C_re = (lambda *s: torch.randn(*s, dtype=torch.bfloat16) * 0.2)(D, P) * (P ** -0.5)
        C_im = (lambda *s: torch.randn(*s, dtype=torch.bfloat16) * 0.2)(D, P) * (P ** -0.5)
        log_dt = (lambda *s: torch.randn(*s, dtype=torch.bfloat16) * 0.2)(P) * 0.3 - 2.0
        Dskip = (lambda *s: torch.randn(*s, dtype=torch.bfloat16) * 0.05)(D)
        return {
            "x": _w((lambda *s: torch.randn(*s, dtype=torch.bfloat16) * 0.05)(B, S, D)),
            "Lambda_re": _w(Lambda_re),
            "Lambda_im": _w(Lambda_im),
            "B_re": _w(B_re),
            "B_im": _w(B_im),
            "C_re": _w(C_re),
            "C_im": _w(C_im),
            "log_dt": _w(log_dt),
            "Dskip": _w(Dskip),
        }
    _A_in = _A_setup()

    def _B_setup():
        B, S, D, F = 1, 2048, 512, 1792
        return {
            "x": _w((lambda *s: torch.randn(*s, dtype=torch.bfloat16) * 0.05)(B, S, D)),
            "w1": _w((lambda *s: torch.randn(*s, dtype=torch.bfloat16) * 0.8)(D, F) * (2.0 / D) ** 0.5),
            "w3": _w((lambda *s: torch.randn(*s, dtype=torch.bfloat16) * 0.8)(D, F) * (2.0 / D) ** 0.5),
            "w2": _w((lambda *s: torch.randn(*s, dtype=torch.bfloat16) * 0.8)(F, D) * (2.0 / F) ** 0.5),
        }
    _B_in = _B_setup()

    return {
        "A_x": _A_in["x"],
        "A_Lambda_re": _A_in["Lambda_re"],
        "A_Lambda_im": _A_in["Lambda_im"],
        "A_B_re": _A_in["B_re"],
        "A_B_im": _A_in["B_im"],
        "A_C_re": _A_in["C_re"],
        "A_C_im": _A_in["C_im"],
        "A_log_dt": _A_in["log_dt"],
        "A_Dskip": _A_in["Dskip"],
        "B_x": _B_in["x"],
        "B_w1": _B_in["w1"],
        "B_w3": _B_in["w3"],
        "B_w2": _B_in["w2"],
        "gate_w": _w((lambda *s: torch.randn(*s, dtype=torch.bfloat16) * 0.05)(512) * 16.0),
    }

def reference(A_x, A_Lambda_re, A_Lambda_im, A_B_re, A_B_im, A_C_re, A_C_im, A_log_dt, A_Dskip, B_x, B_w1, B_w3, B_w2, gate_w):
    def _A_ref(x, Lambda_re, Lambda_im, B_re, B_im, C_re, C_im, log_dt, Dskip):
        Bsz, L, H = x.shape
        Lam = Lambda_re + 1j * Lambda_im
        Bmat = B_re + 1j * B_im
        Cmat = C_re + 1j * C_im
        dt = torch.exp(log_dt)
        Lam_bar = torch.exp(dt * Lam)
        B_bar = ((Lam_bar - 1.0) / Lam)[:, None] * Bmat
        Bu = torch.einsum("bld,pd->blp", x + 0j, B_bar)
        h = torch.zeros_like(Bu[:, 0, :])
        hs = []
        for t in range(L):
            h = Lam_bar[None, :] * h + Bu[:, t, :]
            hs.append(h)
        hseq = torch.stack(hs, 1)
        y = 2.0 * torch.einsum("blp,dp->bld", hseq, Cmat).real + x * Dskip[None, None, :]
        return y

    def _B_ref(x, w1, w3, w2):
        gate = torch.einsum("bsd,df->bsf", x, w1)
        up = torch.einsum("bsd,df->bsf", x, w3)
        h = _silu(gate) * up
        out = torch.einsum("bsf,fd->bsd", h, w2)
        return out

    x = A_x
    g = _sigmoid((x * gate_w).sum(-1, keepdims=True))
    a = _A_ref(x, A_Lambda_re, A_Lambda_im, A_B_re, A_B_im, A_C_re, A_C_im, A_log_dt, A_Dskip)
    b = _B_ref(x, B_w1, B_w3, B_w2)
    return g * a + (1 - g) * b
```

```asm
; @launch grid=(256,1,1) block=(256,1,1) lds=163840
.amdgcn_target "amdgcn-amd-amdhsa--gfx950"
.text
.globl gated_mix__ssm_conv_s5__glu_gated_swiglu__prompt_kernel
.p2align 8
.type gated_mix__ssm_conv_s5__glu_gated_swiglu__prompt_kernel,@function
gated_mix__ssm_conv_s5__glu_gated_swiglu__prompt_kernel:
  s_cmp_ge_u32 s2, 256
  s_cbranch_scc1 END
  s_load_dwordx16 s[64:79], s[0:1], 0
  s_load_dwordx16 s[80:95], s[0:1], 64
  s_load_dwordx2 s[96:97], s[0:1], 128
  v_lshrrev_b32 v1, 6, v0
  s_nop 0
  v_readfirstlane_b32 s56, v1
  v_and_b32 v35, 63, v0
  v_and_b32 v36, 31, v0
  v_bfe_u32 v37, v0, 5, 1
  s_and_b32 s62, s2, 7
  s_lshr_b32 s63, s2, 3
  s_and_b32 s57, s62, 1
  s_lshl_b32 s57, s57, 3
  s_and_b32 s4, s63, 7
  s_add_u32 s57, s57, s4
  s_lshr_b32 s58, s62, 1
  s_lshl_b32 s58, s58, 2
  s_lshr_b32 s4, s63, 3
  s_add_u32 s58, s58, s4
  s_lshr_b32 s59, s58, 2
  s_and_b32 s60, s58, 3
  s_lshl_b32 s61, s56, 10
  s_mov_b32 s7, 4096
  s_mov_b32 s98, 8192
  s_mov_b32 s3, 3216550459
  v_lshrrev_b32 v84, 2, v35
  v_and_b32 v85, 3, v35
  v_lshrrev_b32 v89, 4, v35
  v_xor_b32 v86, v85, v89
  v_lshlrev_b32 v86, 4, v86
  v_and_b32 v87, 3, v84
  v_and_b32 v88, 1, v89
  s_lshl_b32 s62, s57, 2
  s_add_u32 s62, s62, s56
  s_lshl_b32 s63, s62, 5
  v_lshl_add_u32 v90, v88, 4, v87
  v_lshl_add_u32 v90, v37, 2, v90
  v_add_u32 v90, s63, v90
  v_lshl_add_u32 v128, v90, 10, v86
  s_lshl_b32 s4, s58, 5
  v_add_u32 v90, s4, v84
  v_lshl_add_u32 v129, v90, 10, v86
  s_lshr_b32 s6, s56, 1
  s_lshl_b32 s6, s6, 14
  v_add_u32 v129, s6, v129
  s_waitcnt lgkmcnt(0)
  s_mov_b32 s44, s96
  s_mov_b32 s45, s97
  s_mov_b32 s46, 27262976
  s_mov_b32 s47, 0x20000
  s_mov_b32 s8, s64
  s_mov_b32 s9, s65
  s_mov_b32 s10, 2097152
  s_mov_b32 s11, 0x20000
  s_mov_b32 s12, s70
  s_mov_b32 s13, s71
  s_mov_b32 s14, 524288
  s_mov_b32 s15, 0x20000
  s_bitcmp1_b32 s56, 0
  s_cselect_b32 s12, s72, s70
  s_cselect_b32 s13, s73, s71
  s_lshl_b32 s0, s58, 1
  s_add_u32 s0, s0, s57
  s_and_b32 s0, s0, 7
  s_lshl_b32 s1, s0, 7
  s_add_u32 m0, s61, 16384
  s_xor_b32 s5, s1, 0
  buffer_load_dwordx4 v128, s[8:11], s5 offen offset:0 lds
  s_add_u32 m0, s61, 24512
  s_nop 0
  buffer_load_dwordx4 v128, s[8:11], s5 offen offset:64 lds
  s_add_u32 m0, s61, 20480
  s_xor_b32 s5, s1, 8192
  buffer_load_dwordx4 v128, s[8:11], s5 offen offset:0 lds
  s_add_u32 m0, s61, 28608
  s_nop 0
  buffer_load_dwordx4 v128, s[8:11], s5 offen offset:64 lds
  s_add_u32 m0, s61, 32768
  s_xor_b32 s5, s1, 128
  buffer_load_dwordx4 v128, s[8:11], s5 offen offset:0 lds
  s_add_u32 m0, s61, 40896
  s_nop 0
  buffer_load_dwordx4 v128, s[8:11], s5 offen offset:64 lds
  s_add_u32 m0, s61, 36864
  s_xor_b32 s5, s1, 8320
  buffer_load_dwordx4 v128, s[8:11], s5 offen offset:0 lds
  s_add_u32 m0, s61, 44992
  s_nop 0
  buffer_load_dwordx4 v128, s[8:11], s5 offen offset:64 lds
  v_and_b32 v16, 15, v0
  v_lshlrev_b32 v16, 2, v16
  v_mov_b32 v14, 1
  s_cmp_eq_u32 s57, 0
  s_cbranch_scc0 NOCLR
  v_mov_b32 v224, 0
  v_mov_b32 v232, -1
  v_mov_b32 v225, 0
  v_mov_b32 v233, -1
  v_mov_b32 v226, 0
  v_mov_b32 v234, -1
  v_mov_b32 v227, 0
  v_mov_b32 v235, -1
  v_lshlrev_b32 v228, 4, v0
  s_lshl_b32 s16, s58, 12
  s_add_u32 s6, s16, 17825792
  s_add_u32 s16, s16, 16777216
  buffer_store_dwordx4 v[224:227], v228, s[44:47], s6 offen sc1
  buffer_store_dwordx4 v[232:235], v228, s[44:47], s16 offen sc1
NOCLR:
  v_add_lshl_u32 v90, s4, v36, 1
  s_mov_b32 s18, 1024
  s_mov_b32 s19, 0x20000
  s_mov_b32 s16, s66
  s_mov_b32 s17, s67
  buffer_load_ushort v80, v90, s[16:19], 0 offen
  s_mov_b32 s16, s68
  s_mov_b32 s17, s69
  buffer_load_ushort v81, v90, s[16:19], 0 offen
  s_mov_b32 s16, s78
  s_mov_b32 s17, s79
  buffer_load_ushort v82, v90, s[16:19], 0 offen
  s_add_u32 m0, s61, 49152
  s_xor_b32 s5, s1, 0
  buffer_load_dwordx4 v129, s[12:15], s5 offen offset:0 lds
  s_add_u32 m0, s61, 53184
  s_nop 0
  buffer_load_dwordx4 v129, s[12:15], s5 offen offset:64 lds
  s_add_u32 m0, s61, 57344
  s_xor_b32 s5, s1, 128
  buffer_load_dwordx4 v129, s[12:15], s5 offen offset:0 lds
  s_add_u32 m0, s61, 61376
  s_nop 0
  buffer_load_dwordx4 v129, s[12:15], s5 offen offset:64 lds
  s_bfe_u32 s4, s58, 0x10001
  s_lshl_b32 s4, s4, 4
  s_add_u32 s63, s63, s4
  s_lshr_b32 s4, s58, 2
  s_lshl_b32 s4, s4, 2
  s_add_u32 s63, s63, s4
  s_and_b32 s4, s58, 1
  s_lshl_b32 s4, s4, 1
  s_add_u32 s63, s63, s4
  v_add_u32 v90, s63, v37
  v_lshlrev_b32 v91, 4, v36
  v_lshl_add_u32 v90, v90, 10, v91
  buffer_load_dwordx4 v[64:67], v90, s[8:11], 0 offen
  buffer_load_dwordx4 v[68:71], v90, s[8:11], 0 offen offset:512
  s_mov_b32 s16, s90
  s_mov_b32 s17, s91
  s_mov_b32 s18, 1024
  s_mov_b32 s19, 0x20000
  buffer_load_dwordx4 v[72:75], v91, s[16:19], 0 offen
  buffer_load_dwordx4 v[76:79], v91, s[16:19], 0 offen offset:512
  s_add_u32 m0, s61, 65536
  s_xor_b32 s5, s1, 256
  buffer_load_dwordx4 v128, s[8:11], s5 offen offset:0 lds
  s_mov_b32 s20, s74
  s_mov_b32 s21, s75
  s_mov_b32 s22, 524288
  s_mov_b32 s23, 0x20000
  s_mov_b32 s24, s76
  s_mov_b32 s25, s77
  s_mov_b32 s26, 524288
  s_mov_b32 s27, 0x20000
  s_mov_b32 s28, s84
  s_mov_b32 s29, s85
  s_mov_b32 s30, 1835008
  s_mov_b32 s31, 0x20000
  s_mov_b32 s32, s86
  s_add_u32 m0, s61, 73664
  s_nop 0
  buffer_load_dwordx4 v128, s[8:11], s5 offen offset:64 lds
  s_mov_b32 s33, s87
  s_mov_b32 s34, 1835008
  s_mov_b32 s35, 0x20000
  s_mov_b32 s36, s88
  s_mov_b32 s37, s89
  s_mov_b32 s38, 1835008
  s_mov_b32 s39, 0x20000
  s_mov_b32 s40, s92
  s_mov_b32 s41, s93
  s_mov_b32 s42, 4194304
  s_mov_b32 s43, 0x20000
  s_mov_b32 s52, s94
  s_mov_b32 s53, s95
  s_add_u32 m0, s61, 69632
  s_xor_b32 s5, s1, 8448
  buffer_load_dwordx4 v128, s[8:11], s5 offen offset:0 lds
  s_mov_b32 s54, 256
  s_mov_b32 s55, 0x20000
  s_lshl_b32 s4, s58, 12
  s_add_u32 s4, s4, 16777216
  s_add_u32 s48, s96, s4
  s_addc_u32 s49, s97, 0
  s_mov_b32 s50, 4096
  s_mov_b32 s51, 0x20000
  s_lshl_b32 s63, s62, 5
  s_lshl_b32 s4, s58, 1
  s_add_u32 s63, s63, s4
  s_lshl_b32 s63, s63, 2
  s_add_u32 m0, s61, 77760
  s_nop 0
  buffer_load_dwordx4 v128, s[8:11], s5 offen offset:64 lds
  s_add_u32 s63, s63, 16842752
  v_lshl_add_u32 v90, v37, 2, s63
  v_mov_b32 v91, 0x7ffffff0
  v_cmp_eq_u32 vcc, 0, v36
  s_nop 1
  v_cndmask_b32 v136, v91, v90, vcc
  s_lshl_b32 s63, s62, 4
  s_add_u32 s63, s63, s58
  s_lshl_b32 s63, s63, 14
  v_lshl_add_u32 v5, v35, 4, s63
  s_lshl_b32 s63, s57, 2
  s_add_u32 s63, s63, s59
  s_lshl_b32 s63, s63, 2
  s_add_u32 s63, s63, s56
  s_add_u32 m0, s61, 81920
  s_xor_b32 s5, s1, 384
  buffer_load_dwordx4 v128, s[8:11], s5 offen offset:0 lds
  s_lshl_b32 s63, s63, 6
  s_add_u32 s63, s63, 17825792
  v_lshl_add_u32 v6, v85, 2, s63
  s_lshl_b32 s4, s60, 2
  s_add_u32 s63, s63, s4
  v_mov_b32 v90, s63
  v_cmp_eq_u32 vcc, 0, v35
  s_nop 1
  v_cndmask_b32 v7, v91, v90, vcc
  s_lshl_b32 s63, s57, 2
  s_add_u32 s63, s63, s60
  s_lshl_b32 s63, s63, 2
  s_add_u32 s4, s63, s56
  s_add_u32 m0, s61, 90048
  s_nop 0
  buffer_load_dwordx4 v128, s[8:11], s5 offen offset:64 lds
  s_lshl_b32 s16, s4, 6
  s_lshl_b32 s17, s59, 2
  s_add_u32 s16, s16, s17
  s_add_u32 s16, s16, 17842176
  v_mov_b32 v90, s16
  v_cndmask_b32 v39, v91, v90, vcc
  s_lshl_b32 s4, s4, 2
  s_add_u32 s4, s4, s59
  s_lshl_b32 s4, s4, 13
  s_add_u32 s4, s4, 18874368
  s_cmp_eq_u32 s56, s59
  s_cselect_b32 s4, 0x7000000, s4
  v_lshl_add_u32 v41, v35, 4, s4
  s_add_u32 m0, s61, 86016
  s_xor_b32 s5, s1, 8576
  buffer_load_dwordx4 v128, s[8:11], s5 offen offset:0 lds
  s_add_u32 s4, s63, s59
  s_lshl_b32 s16, s4, 6
  s_add_u32 s16, s16, 17842176
  v_lshl_add_u32 v40, v85, 2, s16
  s_lshl_b32 s4, s4, 15
  s_lshl_b32 s16, s56, 11
  s_add_u32 s4, s4, s16
  s_add_u32 s4, s4, 18874368
  v_lshl_add_u32 v42, v35, 4, s4
  s_lshl_b32 s4, s57, 2
  s_add_u32 s4, s4, 17858560
  v_and_b32 v89, 15, v35
  s_add_u32 m0, s61, 94144
  v_lshl_add_u32 v38, v89, 7, s4
  buffer_load_dwordx4 v128, s[8:11], s5 offen offset:64 lds
  s_lshl_b32 s63, s58, 7
  s_add_u32 s63, s63, 17858560
  v_and_b32 v89, 15, v35
  v_lshl_add_u32 v8, v89, 2, s63
  v_cmp_gt_u32 vcc, s57, v89
  s_nop 1
  v_cndmask_b32 v10, 0, v14, vcc
  s_lshl_b32 s4, s57, 2
  s_add_u32 s63, s63, s4
  v_mov_b32 v90, s63
  v_cmp_eq_u32 vcc, 0, v0
  s_nop 1
  v_cndmask_b32 v9, v91, v90, vcc
  s_sub_u32 s63, 15, s57
  s_add_u32 m0, s61, 98304
  s_xor_b32 s5, s1, 256
  buffer_load_dwordx4 v129, s[12:15], s5 offen offset:0 lds
  s_lshl_b32 s63, s63, 8
  v_lshl_add_u32 v90, v36, 3, s63
  v_cmp_gt_u32 vcc, 32, v0
  s_nop 1
  v_cndmask_b32 v11, v91, v90, vcc
  v_lshl_add_u32 v90, v37, 11, v90
  v_add_u32 v12, 0x100, v90
  s_lshl_b32 s63, s62, 18
  s_lshl_b32 s4, s59, 16
  s_add_u32 s63, s63, s4
  v_lshl_add_u32 v3, v35, 4, s63
  s_add_u32 s63, s57, s60
  s_and_b32 s63, s63, 3
  s_lshl_b32 s99, s63, 14
  s_add_u32 m0, s61, 102336
  s_nop 0
  buffer_load_dwordx4 v129, s[12:15], s5 offen offset:64 lds
  s_lshl_b32 s100, s63, 17
  s_xor_b32 s4, s63, 0
  s_lshl_b32 s4, s4, 3
  s_lshr_b32 s66, 370019332, s4
  s_and_b32 s66, s66, 255
  s_lshl_b32 s66, s66, 14
  s_lshr_b32 s78, 336856582, s4
  s_and_b32 s78, s78, 255
  s_lshl_b32 s78, s78, 14
  s_xor_b32 s4, s63, 1
  s_lshl_b32 s4, s4, 3
  s_lshr_b32 s67, 370019332, s4
  s_add_u32 m0, s61, 106496
  s_xor_b32 s5, s1, 384
  buffer_load_dwordx4 v129, s[12:15], s5 offen offset:0 lds
  s_and_b32 s67, s67, 255
  s_lshl_b32 s67, s67, 14
  s_lshr_b32 s79, 336856582, s4
  s_and_b32 s79, s79, 255
  s_lshl_b32 s79, s79, 14
  s_xor_b32 s4, s63, 2
  s_lshl_b32 s4, s4, 3
  s_lshr_b32 s68, 370019332, s4
  s_and_b32 s68, s68, 255
  s_lshl_b32 s68, s68, 14
  s_lshr_b32 s90, 336856582, s4
  s_and_b32 s90, s90, 255
  s_lshl_b32 s90, s90, 14
  s_add_u32 m0, s61, 110528
  s_nop 0
  buffer_load_dwordx4 v129, s[12:15], s5 offen offset:64 lds
  s_xor_b32 s4, s63, 3
  s_lshl_b32 s4, s4, 3
  s_lshr_b32 s69, 370019332, s4
  s_and_b32 s69, s69, 255
  s_lshl_b32 s69, s69, 14
  s_lshr_b32 s91, 336856582, s4
  s_and_b32 s91, s91, 255
  s_lshl_b32 s91, s91, 14
  s_lshr_b32 s63, s58, 2
  s_mul_i32 s63, s63, 896
  s_and_b32 s4, s58, 3
  v_mul_u32_u24 v89, 3584, v84
  s_add_u32 m0, s61, 114688
  s_xor_b32 s5, s1, 512
  buffer_load_dwordx4 v128, s[8:11], s5 offen offset:0 lds
  v_lshl_add_u32 v89, v85, 4, v89
  s_mul_i32 s6, s56, 57344
  s_lshl_b32 s16, s4, 8
  s_add_u32 s16, s16, s63
  s_add_u32 s16, s16, s6
  v_add_u32 v130, s16, v89
  s_and_b32 s6, s0, 1
  s_lshl_b32 s6, s6, 1
  s_xor_b32 s6, s6, s56
  s_mul_i32 s6, s6, 114688
  s_add_u32 s63, s63, s6
  s_lshl_b32 s4, s4, 3
  s_lshr_b32 s16, 370019332, s4
  s_add_u32 m0, s61, 122816
  s_nop 0
  buffer_load_dwordx4 v128, s[8:11], s5 offen offset:64 lds
  s_and_b32 s16, s16, 255
  s_lshl_b32 s16, s16, 5
  s_add_u32 s16, s16, s63
  v_add_u32 v176, s16, v89
  v_add_u32 v179, 57344, v176
  s_lshr_b32 s16, 353634054, s4
  s_and_b32 s16, s16, 255
  s_lshl_b32 s16, s16, 5
  s_add_u32 s63, s16, s63
  v_lshrrev_b32 v89, 1, v35
  v_and_b32 v90, 1, v35
  v_lshl_add_u32 v90, v90, 4, s63
  v_mul_u32_u24 v177, 3584, v89
  s_add_u32 m0, s61, 118784
  s_xor_b32 s5, s1, 8704
  buffer_load_dwordx4 v128, s[8:11], s5 offen offset:0 lds
  v_add_u32 v177, v177, v90
  v_xor_b32 v89, 4, v89
  v_mul_u32_u24 v178, 3584, v89
  v_add_u32 v178, v178, v90
  s_mul_i32 s63, s59, 458752
  s_lshl_b32 s4, s60, 8
  s_add_u32 s63, s63, s4
  s_and_b32 s4, s56, 1
  s_lshl_b32 s4, s4, 7
  s_add_u32 s63, s63, s4
  v_lshlrev_b32 v89, 10, v84
  s_add_u32 m0, s61, 126912
  v_lshl_add_u32 v90, v85, 4, v89
  buffer_load_dwordx4 v128, s[8:11], s5 offen offset:64 lds
  s_lshr_b32 s4, s56, 1
  s_lshl_b32 s4, s4, 14
  s_add_u32 s16, s63, s4
  v_add_u32 v1, s16, v90
  s_and_b32 s16, s99, 16384
  s_xor_b32 s16, s16, s4
  s_add_u32 s16, s16, s63
  v_add_u32 v4, s16, v90
  s_lshl_b32 s63, s60, 17
  s_lshl_b32 s4, s56, 15
  s_add_u32 s63, s63, s4
  s_lshl_b32 s4, s59, 8
  s_add_u32 s63, s63, s4
  s_add_u32 m0, s61, 131072
  s_xor_b32 s5, s1, 640
  buffer_load_dwordx4 v128, s[8:11], s5 offen offset:0 lds
  s_lshr_b32 s4, s99, 8
  s_add_u32 s63, s63, s4
  v_add3_u32 v2, v89, v86, s63
  v_xor_b32 v43, 64, v2
  v_xor_b32 v44, 128, v2
  v_xor_b32 v45, 192, v2
  s_lshl_b32 s63, s56, 1
  v_add_u32 v135, s63, v37
  v_lshlrev_b32 v15, 3, v36
  v_lshl_add_u32 v137, v135, 8, v15
  v_bfe_u32 v89, v36, 1, 2
  s_add_u32 m0, s61, 139200
  v_lshlrev_b32 v90, 6, v36
  buffer_load_dwordx4 v128, s[8:11], s5 offen offset:64 lds
  v_lshl_add_u32 v90, v37, 3, v90
  s_lshl_b32 s16, s56, 12
  v_add_u32 v90, s16, v90
  v_lshl_add_u32 v29, v89, 4, v90
  v_xor_b32 v30, 16, v29
  v_xor_b32 v31, 32, v29
  v_xor_b32 v32, 48, v29
  v_lshl_add_u32 v89, v37, 3, v87
  v_lshrrev_b32 v90, 1, v85
  v_lshl_add_u32 v90, v88, 1, v90
  v_lshrrev_b32 v91, 1, v87
  v_xor_b32 v90, v90, v91
  v_lshlrev_b32 v90, 4, v90
  s_add_u32 m0, s61, 135168
  s_xor_b32 s5, s1, 8832
  buffer_load_dwordx4 v128, s[8:11], s5 offen offset:0 lds
  v_lshl_add_u32 v90, v89, 6, v90
  v_and_b32 v91, 1, v85
  v_lshl_add_u32 v90, v91, 3, v90
  v_add_u32 v33, s16, v90
  v_xor_b32 v34, 0x120, v33
  v_lshlrev_b32 v91, 3, v85
  v_lshl_add_u32 v90, v88, 5, v91
  v_lshl_add_u32 v92, v89, 6, v90
  v_add_u32 v180, 65536, v92
  v_add_u32 v181, 131072, v92
  v_add_u32 v182, 0, v92
  v_lshl_add_u32 v92, v37, 2, v87
  s_add_u32 m0, s61, 143296
  v_lshl_add_u32 v92, v92, 6, v90
  buffer_load_dwordx4 v128, s[8:11], s5 offen offset:64 lds
  s_lshr_b32 s16, s56, 1
  s_lshl_b32 s16, s16, 10
  s_add_u32 s63, s16, 131072
  v_add_u32 v53, s63, v92
  s_add_u32 s63, s16, 0
  v_add_u32 v54, s63, v92
  s_add_u32 s63, s16, 65536
  v_add_u32 v55, s63, v92
  v_lshl_add_u32 v92, v89, 5, v91
  v_mul_u32_u24 v93, 0x1080, v88
  v_add_u32 v92, v92, v93
  v_add_u32 v183, 65536, v92
  s_add_u32 m0, s61, 147456
  s_xor_b32 s5, s1, 512
  buffer_load_dwordx4 v129, s[12:15], s5 offen offset:0 lds
  v_add_u32 v185, 131072, v92
  v_xor_b32 v92, 0x80, v92
  v_add_u32 v184, 65536, v92
  v_add_u32 v186, 131072, v92
  v_bfe_u32 v89, v36, 2, 2
  v_xor_b32 v89, v89, v37
  v_lshlrev_b32 v89, 4, v89
  v_and_b32 v90, 15, v36
  v_lshl_add_u32 v89, v90, 6, v89
  v_lshl_add_u32 v92, v88, 11, v89
  v_add_u32 v146, 0, v92
  v_add_u32 v150, 65536, v92
  s_add_u32 m0, s61, 151488
  v_add_u32 v153, 131072, v92
  buffer_load_dwordx4 v129, s[12:15], s5 offen offset:64 lds
  v_xor_b32 v92, 32, v92
  v_add_u32 v148, 0, v92
  v_add_u32 v152, 65536, v92
  v_add_u32 v154, 131072, v92
  v_lshl_add_u32 v92, v88, 12, v89
  s_lshr_b32 s16, s56, 1
  s_lshl_b32 s16, s16, 11
  s_add_u32 s63, s61, 0
  v_add_u32 v145, s63, v92
  s_add_u32 s63, s61, 65536
  v_add_u32 v149, s63, v92
  s_add_u32 s63, s61, 131072
  s_add_u32 m0, s61, 155648
  s_xor_b32 s5, s1, 640
  buffer_load_dwordx4 v129, s[12:15], s5 offen offset:0 lds
  v_add_u32 v155, s63, v92
  s_add_u32 s63, s16, 0
  v_add_u32 v46, s63, v92
  s_add_u32 s63, s16, 65536
  v_add_u32 v50, s63, v92
  v_xor_b32 v92, 32, v92
  s_add_u32 s63, s61, 0
  v_add_u32 v147, s63, v92
  s_add_u32 s63, s61, 65536
  v_add_u32 v151, s63, v92
  s_add_u32 s63, s61, 131072
  v_add_u32 v156, s63, v92
  s_add_u32 s63, s16, 0
  s_add_u32 m0, s61, 159680
  s_nop 0
  buffer_load_dwordx4 v129, s[12:15], s5 offen offset:64 lds
  v_add_u32 v48, s63, v92
  s_add_u32 s63, s16, 65536
  v_add_u32 v52, s63, v92
  v_lshlrev_b32 v92, 4, v35
  s_and_b32 s16, s56, 1
  s_lshl_b32 s16, s16, 11
  s_add_u32 s63, s16, 131072
  v_add_u32 v47, s63, v92
  s_add_u32 s63, s16, 0
  v_add_u32 v49, s63, v92
  s_add_u32 s63, s16, 65536
  v_add_u32 v51, s63, v92
  s_waitcnt vmcnt(28)
  s_barrier
  ds_read_b128 a[0:3], v145 offset:16384
  ds_read_b128 a[192:195], v146 offset:49152
  ds_read_b128 a[196:199], v146 offset:50176
  ds_read_b128 a[4:7], v147 offset:16384
  ds_read_b128 a[200:203], v148 offset:49152
  ds_read_b128 a[204:207], v148 offset:50176
  ds_read_b128 a[8:11], v145 offset:24576
  ds_read_b128 a[208:211], v146 offset:53248
  ds_read_b128 a[212:215], v146 offset:54272
  s_or_b32 s62, s57, s56
  s_cmp_eq_u32 s62, 0
  s_cbranch_scc0 NORDY
  v_lshlrev_b32 v224, 12, v35
  s_lshl_b32 s62, s58, 2
  buffer_store_dword v14, v224, s[52:55], s62 offen sc1
NORDY:
  s_waitcnt lgkmcnt(6)
  v_mfma_f32_32x32x16_bf16 v[192:207], a[0:3], a[192:195], 0
  ds_read_b128 a[12:15], v147 offset:24576
  ds_read_b128 a[216:219], v148 offset:53248
  v_mfma_f32_32x32x16_bf16 v[208:223], a[0:3], a[196:199], 0
  ds_read_b128 a[220:223], v148 offset:54272
  s_waitcnt lgkmcnt(8)
  s_add_u32 m0, s61, 16384
  s_xor_b32 s5, s1, 768
  buffer_load_dwordx4 v128, s[8:11], s5 offen offset:0 lds
  s_waitcnt lgkmcnt(6)
  v_mfma_f32_32x32x16_bf16 v[192:207], a[4:7], a[200:203], v[192:207]
  ds_read_b128 a[16:19], v145 offset:32768
  ds_read_b128 a[224:227], v146 offset:57344
  s_waitcnt lgkmcnt(4)
  s_add_u32 m0, s61, 24512
  s_nop 0
  buffer_load_dwordx4 v128, s[8:11], s5 offen offset:64 lds
  v_mfma_f32_32x32x16_bf16 v[208:223], a[4:7], a[204:207], v[208:223]
  ds_read_b128 a[228:231], v146 offset:58368
  s_add_u32 m0, s61, 20480
  s_xor_b32 s5, s1, 8960
  buffer_load_dwordx4 v128, s[8:11], s5 offen offset:0 lds
  v_mfma_f32_32x32x16_bf16 v[192:207], a[8:11], a[208:211], v[192:207]
  ds_read_b128 a[20:23], v147 offset:32768
  s_add_u32 m0, s61, 28608
  ds_read_b128 a[232:235], v148 offset:57344
  buffer_load_dwordx4 v128, s[8:11], s5 offen offset:64 lds
  v_mfma_f32_32x32x16_bf16 v[208:223], a[8:11], a[212:215], v[208:223]
  ds_read_b128 a[236:239], v148 offset:58368
  s_waitcnt vmcnt(31)
  v_lshlrev_b32 v85, 16, v64
  s_waitcnt vmcnt(29)
  v_lshlrev_b32 v86, 16, v72
  v_and_b32 v87, 0xffff0000, v64
  v_and_b32 v88, 0xffff0000, v72
  v_mul_f32 v85, v85, v86
  v_mul_f32 v87, v87, v88
  s_waitcnt lgkmcnt(6)
  v_mfma_f32_32x32x16_bf16 v[192:207], a[12:15], a[216:219], v[192:207]
  ds_read_b128 a[24:27], v145 offset:40960
  ds_read_b128 a[240:243], v146 offset:61440
  v_cvt_pk_bf16_f32 v85, v85, v87
  v_lshlrev_b32 v86, 16, v85
  v_and_b32 v85, 0xffff0000, v85
  v_add_f32 v84, v85, v86
  v_lshlrev_b32 v85, 16, v65
  v_mfma_f32_32x32x16_bf16 v[208:223], a[12:15], a[220:223], v[208:223]
  ds_read_b128 a[244:247], v146 offset:62464
  v_lshlrev_b32 v86, 16, v73
  v_and_b32 v87, 0xffff0000, v65
  v_and_b32 v88, 0xffff0000, v73
  v_mul_f32 v85, v85, v86
  v_mul_f32 v87, v87, v88
  v_cvt_pk_bf16_f32 v85, v85, v87
  v_lshlrev_b32 v86, 16, v85
  s_waitcnt lgkmcnt(6)
  v_mfma_f32_32x32x16_bf16 v[192:207], a[16:19], a[224:227], v[192:207]
  ds_read_b128 a[28:31], v147 offset:40960
  ds_read_b128 a[248:251], v148 offset:61440
  v_and_b32 v85, 0xffff0000, v85
  v_add_f32 v85, v85, v86
  v_add_f32 v84, v84, v85
  v_lshlrev_b32 v85, 16, v66
  v_lshlrev_b32 v86, 16, v74
  v_mfma_f32_32x32x16_bf16 v[208:223], a[16:19], a[228:231], v[208:223]
  ds_read_b128 a[252:255], v148 offset:62464
  s_waitcnt lgkmcnt(8)
  s_add_u32 m0, s61, 32768
  s_xor_b32 s5, s1, 896
  buffer_load_dwordx4 v128, s[8:11], s5 offen offset:0 lds
  s_waitcnt lgkmcnt(6)
  v_mfma_f32_32x32x16_bf16 v[192:207], a[20:23], a[232:235], v[192:207]
  s_waitcnt vmcnt(17) lgkmcnt(0)
  s_barrier
  ds_read_b128 a[32:35], v149 offset:0
  s_add_u32 m0, s61, 40896
  ds_read_b128 a[192:195], v150 offset:32768
  buffer_load_dwordx4 v128, s[8:11], s5 offen offset:64 lds
  v_mfma_f32_32x32x16_bf16 v[208:223], a[20:23], a[236:239], v[208:223]
  ds_read_b128 a[196:199], v150 offset:33792
  s_add_u32 m0, s61, 36864
  s_xor_b32 s5, s1, 9088
  buffer_load_dwordx4 v128, s[8:11], s5 offen offset:0 lds
  v_mfma_f32_32x32x16_bf16 v[192:207], a[24:27], a[240:243], v[192:207]
  ds_read_b128 a[36:39], v151 offset:0
  s_add_u32 m0, s61, 44992
  ds_read_b128 a[200:203], v152 offset:32768
  buffer_load_dwordx4 v128, s[8:11], s5 offen offset:64 lds
  v_mfma_f32_32x32x16_bf16 v[208:223], a[24:27], a[244:247], v[208:223]
  ds_read_b128 a[204:207], v152 offset:33792
  s_add_u32 m0, s61, 49152
  s_xor_b32 s5, s1, 768
  buffer_load_dwordx4 v129, s[12:15], s5 offen offset:0 lds
  v_mfma_f32_32x32x16_bf16 v[192:207], a[28:31], a[248:251], v[192:207]
  ds_read_b128 a[40:43], v149 offset:8192
  s_add_u32 m0, s61, 53184
  ds_read_b128 a[208:211], v150 offset:36864
  buffer_load_dwordx4 v129, s[12:15], s5 offen offset:64 lds
  v_mfma_f32_32x32x16_bf16 v[208:223], a[28:31], a[252:255], v[208:223]
  ds_read_b128 a[212:215], v150 offset:37888
  s_add_u32 m0, s61, 57344
  s_xor_b32 s5, s1, 896
  buffer_load_dwordx4 v129, s[12:15], s5 offen offset:0 lds
  s_waitcnt lgkmcnt(6)
  v_mfma_f32_32x32x16_bf16 v[192:207], a[32:35], a[192:195], v[192:207]
  ds_read_b128 a[44:47], v151 offset:8192
  s_add_u32 m0, s61, 61376
  ds_read_b128 a[216:219], v152 offset:36864
  buffer_load_dwordx4 v129, s[12:15], s5 offen offset:64 lds
  v_mfma_f32_32x32x16_bf16 v[208:223], a[32:35], a[196:199], v[208:223]
  ds_read_b128 a[220:223], v152 offset:37888
  v_and_b32 v87, 0xffff0000, v66
  v_and_b32 v88, 0xffff0000, v74
  v_mul_f32 v85, v85, v86
  v_mul_f32 v87, v87, v88
  v_cvt_pk_bf16_f32 v85, v85, v87
  v_lshlrev_b32 v86, 16, v85
  s_waitcnt lgkmcnt(6)
  v_mfma_f32_32x32x16_bf16 v[192:207], a[36:39], a[200:203], v[192:207]
  ds_read_b128 a[48:51], v149 offset:16384
  ds_read_b128 a[224:227], v150 offset:40960
  v_and_b32 v85, 0xffff0000, v85
  v_add_f32 v85, v85, v86
  v_add_f32 v84, v84, v85
  v_lshlrev_b32 v85, 16, v67
  v_lshlrev_b32 v86, 16, v75
  v_mfma_f32_32x32x16_bf16 v[208:223], a[36:39], a[204:207], v[208:223]
  ds_read_b128 a[228:231], v150 offset:41984
  v_and_b32 v87, 0xffff0000, v67
  v_and_b32 v88, 0xffff0000, v75
  v_mul_f32 v85, v85, v86
  v_mul_f32 v87, v87, v88
  v_cvt_pk_bf16_f32 v85, v85, v87
  v_lshlrev_b32 v86, 16, v85
  s_waitcnt lgkmcnt(6)
  v_mfma_f32_32x32x16_bf16 v[192:207], a[40:43], a[208:211], v[192:207]
  ds_read_b128 a[52:55], v151 offset:16384
  ds_read_b128 a[232:235], v152 offset:40960
  v_and_b32 v85, 0xffff0000, v85
  v_add_f32 v85, v85, v86
  v_add_f32 v84, v84, v85
  v_lshlrev_b32 v85, 16, v68
  v_lshlrev_b32 v86, 16, v76
  v_and_b32 v87, 0xffff0000, v68
  v_mfma_f32_32x32x16_bf16 v[208:223], a[40:43], a[212:215], v[208:223]
  ds_read_b128 a[236:239], v152 offset:41984
  v_and_b32 v88, 0xffff0000, v76
  v_mul_f32 v85, v85, v86
  v_mul_f32 v87, v87, v88
  v_cvt_pk_bf16_f32 v85, v85, v87
  v_lshlrev_b32 v86, 16, v85
  v_and_b32 v85, 0xffff0000, v85
  s_waitcnt lgkmcnt(6)
  v_mfma_f32_32x32x16_bf16 v[192:207], a[44:47], a[216:219], v[192:207]
  ds_read_b128 a[56:59], v149 offset:24576
  ds_read_b128 a[240:243], v150 offset:45056
  v_add_f32 v85, v85, v86
  v_add_f32 v84, v84, v85
  v_lshlrev_b32 v85, 16, v69
  v_lshlrev_b32 v86, 16, v77
  v_and_b32 v87, 0xffff0000, v69
  v_mfma_f32_32x32x16_bf16 v[208:223], a[44:47], a[220:223], v[208:223]
  ds_read_b128 a[244:247], v150 offset:46080
  v_and_b32 v88, 0xffff0000, v77
  v_mul_f32 v85, v85, v86
  v_mul_f32 v87, v87, v88
  v_cvt_pk_bf16_f32 v85, v85, v87
  v_lshlrev_b32 v86, 16, v85
  v_and_b32 v85, 0xffff0000, v85
  s_waitcnt lgkmcnt(6)
  v_mfma_f32_32x32x16_bf16 v[192:207], a[48:51], a[224:227], v[192:207]
  ds_read_b128 a[60:63], v151 offset:24576
  ds_read_b128 a[248:251], v152 offset:45056
  s_add_u32 m0, s61, 65536
  s_xor_b32 s5, s0, 0
  s_mul_i32 s5, s5, 229376
  buffer_load_dwordx4 v130, s[28:31], s5 offen offset:0 lds
  v_mfma_f32_32x32x16_bf16 v[208:223], a[48:51], a[228:231], v[208:223]
  s_add_u32 m0, s61, 69568
  ds_read_b128 a[252:255], v152 offset:46080
  buffer_load_dwordx4 v130, s[28:31], s5 offen offset:64 lds
  s_waitcnt lgkmcnt(6)
  v_mfma_f32_32x32x16_bf16 v[192:207], a[52:55], a[232:235], v[192:207]
  s_waitcnt vmcnt(14) lgkmcnt(0)
  s_barrier
  ds_read_b128 a[64:67], v149 offset:49152
  s_add_u32 m0, s61, 73728
  ds_read_b128 a[192:195], v153 offset:16384
  buffer_load_dwordx4 v130, s[32:35], s5 offen offset:0 lds
  v_mfma_f32_32x32x16_bf16 v[208:223], a[52:55], a[236:239], v[208:223]
  s_add_u32 m0, s61, 77760
  ds_read_b128 a[196:199], v153 offset:17408
  buffer_load_dwordx4 v130, s[32:35], s5 offen offset:64 lds
  v_mfma_f32_32x32x16_bf16 v[192:207], a[56:59], a[240:243], v[192:207]
  ds_read_b128 a[68:71], v151 offset:49152
  ds_read_b128 a[200:203], v154 offset:16384
  v_add_f32 v85, v85, v86
  v_add_f32 v84, v84, v85
  v_lshlrev_b32 v85, 16, v70
  v_lshlrev_b32 v86, 16, v78
  v_and_b32 v87, 0xffff0000, v70
  v_and_b32 v88, 0xffff0000, v78
  v_mfma_f32_32x32x16_bf16 v[208:223], a[56:59], a[244:247], v[208:223]
  ds_read_b128 a[204:207], v154 offset:17408
  v_mul_f32 v85, v85, v86
  v_mul_f32 v87, v87, v88
  v_cvt_pk_bf16_f32 v85, v85, v87
  v_lshlrev_b32 v86, 16, v85
  v_and_b32 v85, 0xffff0000, v85
  v_add_f32 v85, v85, v86
  v_mfma_f32_32x32x16_bf16 v[192:207], a[60:63], a[248:251], v[192:207]
  ds_read_b128 a[72:75], v149 offset:57344
  ds_read_b128 a[208:211], v153 offset:20480
  v_add_f32 v84, v84, v85
  v_lshlrev_b32 v85, 16, v71
  v_lshlrev_b32 v86, 16, v79
  v_and_b32 v87, 0xffff0000, v71
  v_and_b32 v88, 0xffff0000, v79
  v_mfma_f32_32x32x16_bf16 v[208:223], a[60:63], a[252:255], v[208:223]
  ds_read_b128 a[212:215], v153 offset:21504
  v_mul_f32 v85, v85, v86
  v_mul_f32 v87, v87, v88
  v_cvt_pk_bf16_f32 v85, v85, v87
  v_lshlrev_b32 v86, 16, v85
  v_and_b32 v85, 0xffff0000, v85
  v_add_f32 v85, v85, v86
  s_waitcnt lgkmcnt(6)
  v_mfma_f32_32x32x16_bf16 v[192:207], a[64:67], a[192:195], v[192:207]
  ds_read_b128 a[76:79], v151 offset:57344
  ds_read_b128 a[216:219], v154 offset:20480
  v_add_f32 v84, v84, v85
  s_nop 1
  v_add_f32_dpp v84, v84, v84 quad_perm:[1,0,3,2] row_mask:0xf bank_mask:0xf
  s_nop 1
  v_add_f32_dpp v84, v84, v84 quad_perm:[2,3,0,1] row_mask:0xf bank_mask:0xf
  s_nop 1
  v_add_f32_dpp v84, v84, v84 row_half_mirror row_mask:0xf bank_mask:0xf
  s_nop 1
  v_add_f32_dpp v84, v84, v84 row_mirror row_mask:0xf bank_mask:0xf
  v_mfma_f32_32x32x16_bf16 v[208:223], a[64:67], a[196:199], v[208:223]
  ds_read_b128 a[220:223], v154 offset:21504
  v_mov_b32 v85, v84
  s_nop 1
  v_permlane16_swap_b32 v84, v85
  v_add_f32 v84, v84, v85
  v_cvt_pk_bf16_f32 v84, v84, v84
  v_lshlrev_b32 v84, 16, v84
  v_mul_f32 v84, s3, v84
  s_waitcnt lgkmcnt(6)
  v_mfma_f32_32x32x16_bf16 v[192:207], a[68:71], a[200:203], v[192:207]
  ds_read_b128 a[80:83], v155 offset:0
  ds_read_b128 a[224:227], v153 offset:24576
  v_exp_f32 v84, v84
  s_nop 0
  v_add_f32 v84, 1.0, v84
  v_rcp_f32 v84, v84
  s_nop 0
  v_cvt_pk_bf16_f32 v84, v84, v84
  v_mfma_f32_32x32x16_bf16 v[208:223], a[68:71], a[204:207], v[208:223]
  ds_read_b128 a[228:231], v153 offset:25600
  v_lshlrev_b32 v84, 16, v84
  buffer_store_dword v84, v136, s[44:47], 0 offen sc1
  s_waitcnt lgkmcnt(6)
  v_mfma_f32_32x32x16_bf16 v[192:207], a[72:75], a[208:211], v[192:207]
  ds_read_b128 a[84:87], v156 offset:0
  ds_read_b128 a[232:235], v154 offset:24576
  v_lshlrev_b32 v80, 16, v80
  v_lshlrev_b32 v81, 16, v81
  v_lshlrev_b32 v82, 16, v82
  v_mul_f32 v82, 0x3fb8aa3b, v82
  v_mfma_f32_32x32x16_bf16 v[208:223], a[72:75], a[212:215], v[208:223]
  ds_read_b128 a[236:239], v154 offset:25600
  v_exp_f32 v82, v82
  s_nop 0
  v_cvt_pk_bf16_f32 v82, v82, v82
  v_lshlrev_b32 v82, 16, v82
  v_mul_f32 v85, v82, v80
  v_mul_f32 v86, v82, v81
  s_waitcnt lgkmcnt(6)
  v_mfma_f32_32x32x16_bf16 v[192:207], a[76:79], a[216:219], v[192:207]
  ds_read_b128 a[88:91], v155 offset:8192
  ds_read_b128 a[240:243], v153 offset:28672
  v_mul_f32 v85, 0x3fb8aa3b, v85
  v_mul_f32 v86, 0.15915494, v86
  v_exp_f32 v85, v85
  v_rndne_f32 v87, v86
  v_sub_f32 v86, v86, v87
  v_mfma_f32_32x32x16_bf16 v[208:223], a[76:79], a[220:223], v[208:223]
  ds_read_b128 a[244:247], v153 offset:29696
  v_cos_f32 v87, v86
  v_sin_f32 v88, v86
  v_mul_f32 v89, v80, v80
  v_fmac_f32 v89, v81, v81
  s_lshl_b32 s6, s2, 2
  s_add_u32 s6, s6, s56
  s_mov_b32 s19, 0x20000
  s_mov_b32 s18, 1835008
  s_cmp_ge_u32 s6, 512
  s_cselect_b32 s16, s32, s28
  s_cselect_b32 s17, s33, s29
  s_and_b32 s6, s6, 511
  s_mul_i32 s6, s6, 3584
  v_min_u32 v142, 11, v35
  v_mul_u32_u24 v141, 43, v142
  v_lshrrev_b32 v141, 7, v141
  v_lshl_add_u32 v142, v142, 1, v141
  v_lshlrev_b32 v142, 7, v142
  buffer_load_dword v142, v142, s[16:19], s6 offen offset:128
  s_waitcnt lgkmcnt(6)
  v_mfma_f32_32x32x16_bf16 v[192:207], a[80:83], a[224:227], v[192:207]
  ds_read_b128 a[92:95], v156 offset:8192
  ds_read_b128 a[248:251], v154 offset:28672
  s_add_u32 m0, s61, 81920
  s_xor_b32 s5, s0, 1
  s_mul_i32 s5, s5, 229376
  buffer_load_dwordx4 v130, s[28:31], s5 offen offset:0 lds
  v_mfma_f32_32x32x16_bf16 v[208:223], a[80:83], a[228:231], v[208:223]
  s_add_u32 m0, s61, 85952
  ds_read_b128 a[252:255], v154 offset:29696
  buffer_load_dwordx4 v130, s[28:31], s5 offen offset:64 lds
  s_waitcnt lgkmcnt(6)
  v_mfma_f32_32x32x16_bf16 v[192:207], a[84:87], a[232:235], v[192:207]
  s_waitcnt vmcnt(8) lgkmcnt(0)
  s_barrier
  ds_read_b128 a[96:99], v145 offset:16384
  s_add_u32 m0, s61, 90112
  ds_read_b128 a[192:195], v146 offset:49152
  buffer_load_dwordx4 v130, s[32:35], s5 offen offset:0 lds
  v_mfma_f32_32x32x16_bf16 v[208:223], a[84:87], a[236:239], v[208:223]
  s_add_u32 m0, s61, 94144
  ds_read_b128 a[196:199], v146 offset:50176
  buffer_load_dwordx4 v130, s[32:35], s5 offen offset:64 lds
  v_mfma_f32_32x32x16_bf16 v[192:207], a[88:91], a[240:243], v[192:207]
  ds_read_b128 a[100:103], v147 offset:16384
  ds_read_b128 a[200:203], v148 offset:49152
  v_mul_f32 v18, v85, v87
  v_mul_f32 v19, v85, v88
  v_rcp_f32 v89, v89
  v_sub_f32 v20, 0, v19
  v_mfma_f32_32x32x16_bf16 v[208:223], a[88:91], a[244:247], v[208:223]
  ds_read_b128 a[204:207], v148 offset:50176
  v_add_f32 v85, -1.0, v18
  v_add_f32 v89, v89, v89
  v_mul_f32 v131, v85, v80
  v_mul_f32 v132, v19, v80
  v_fmac_f32 v131, v19, v81
  v_fma_f32 v132, -v85, v81, v132
  v_mfma_f32_32x32x16_bf16 v[192:207], a[92:95], a[248:251], v[192:207]
  ds_read_b128 a[104:107], v145 offset:24576
  ds_read_b128 a[208:211], v146 offset:53248
  v_mul_f32 v131, v131, v89
  v_mul_f32 v132, v132, v89
  v_mul_f32 v85, v18, v18
  v_add_f32 v86, v18, v18
  v_fma_f32 v85, -v19, v19, v85
  v_mfma_f32_32x32x16_bf16 v[208:223], a[92:95], a[252:255], v[208:223]
  ds_read_b128 a[212:215], v146 offset:54272
  v_mul_f32 v86, v86, v19
  v_mul_f32 v87, v85, v85
  v_add_f32 v88, v85, v85
  v_fma_f32 v87, -v86, v86, v87
  v_mul_f32 v88, v88, v86
  v_mul_f32 v85, v87, v87
  v_add_f32 v86, v87, v87
  s_waitcnt lgkmcnt(6)
  v_mfma_f32_32x32x16_bf16 v[192:207], a[96:99], a[192:195], v[192:207]
  ds_read_b128 a[108:111], v147 offset:24576
  ds_read_b128 a[216:219], v148 offset:53248
  v_fma_f32 v85, -v88, v88, v85
  v_mul_f32 v86, v86, v88
  v_mul_f32 v133, v85, v85
  v_add_f32 v134, v85, v85
  v_fma_f32 v133, -v86, v86, v133
  v_mfma_f32_32x32x16_bf16 v[208:223], a[96:99], a[196:199], v[208:223]
  ds_read_b128 a[220:223], v148 offset:54272
  v_mul_f32 v134, v134, v86
  v_cmp_eq_u32 vcc, 0, v37
  s_nop 1
  v_cndmask_b32 v89, v133, 1.0, vcc
  v_cndmask_b32 v90, v134, 0, vcc
  v_mul_f32 v85, v133, v133
  v_add_f32 v86, v133, v133
  s_waitcnt lgkmcnt(6)
  v_mfma_f32_32x32x16_bf16 v[192:207], a[100:103], a[200:203], v[192:207]
  ds_read_b128 a[112:115], v145 offset:32768
  ds_read_b128 a[224:227], v146 offset:57344
  v_fma_f32 v85, -v134, v134, v85
  v_mul_f32 v86, v86, v134
  v_and_b32 v87, 2, v135
  v_cmp_eq_u32 vcc, 0, v87
  s_nop 1
  v_cndmask_b32 v87, v85, 1.0, vcc
  v_cndmask_b32 v88, v86, 0, vcc
  v_mfma_f32_32x32x16_bf16 v[208:223], a[100:103], a[204:207], v[208:223]
  ds_read_b128 a[228:231], v146 offset:58368
  v_mul_f32 v27, v89, v87
  v_mul_f32 v28, v89, v88
  v_fma_f32 v27, -v90, v88, v27
  v_fmac_f32 v28, v90, v87
  v_mul_f32 v87, v85, v85
  s_waitcnt lgkmcnt(6)
  v_mfma_f32_32x32x16_bf16 v[192:207], a[104:107], a[208:211], v[192:207]
  ds_read_b128 a[116:119], v147 offset:32768
  ds_read_b128 a[232:235], v148 offset:57344
  v_add_f32 v88, v85, v85
  v_fma_f32 v87, -v86, v86, v87
  v_mul_f32 v88, v88, v86
  v_cmp_gt_u32 vcc, 4, v135
  s_nop 1
  v_cndmask_b32 v85, v87, 1.0, vcc
  v_cndmask_b32 v86, v88, 0, vcc
  v_mfma_f32_32x32x16_bf16 v[208:223], a[104:107], a[212:215], v[208:223]
  ds_read_b128 a[236:239], v148 offset:58368
  v_mul_f32 v23, v27, v85
  v_mul_f32 v24, v27, v86
  v_fma_f32 v23, -v28, v86, v23
  v_fmac_f32 v24, v28, v85
  v_mul_f32 v25, v87, v87
  v_add_f32 v26, v87, v87
  s_waitcnt lgkmcnt(6)
  v_mfma_f32_32x32x16_bf16 v[192:207], a[108:111], a[216:219], v[192:207]
  ds_read_b128 a[120:123], v145 offset:40960
  ds_read_b128 a[240:243], v146 offset:61440
  v_fma_f32 v25, -v88, v88, v25
  v_mul_f32 v26, v26, v88
  v_mul_f32 v85, v25, v25
  v_add_f32 v86, v25, v25
  v_fma_f32 v85, -v26, v26, v85
  v_mfma_f32_32x32x16_bf16 v[208:223], a[108:111], a[220:223], v[208:223]
  ds_read_b128 a[244:247], v146 offset:62464
  v_mul_f32 v86, v86, v26
  v_mul_f32 v87, v85, v85
  v_add_f32 v88, v85, v85
  v_fma_f32 v87, -v86, v86, v87
  v_mul_f32 v88, v88, v86
  v_mul_f32 v85, v87, v87
  s_waitcnt lgkmcnt(6)
  v_mfma_f32_32x32x16_bf16 v[192:207], a[112:115], a[224:227], v[192:207]
  ds_read_b128 a[124:127], v147 offset:40960
  ds_read_b128 a[248:251], v148 offset:61440
  s_add_u32 m0, s61, 98304
  s_xor_b32 s5, s0, 2
  s_mul_i32 s5, s5, 229376
  buffer_load_dwordx4 v130, s[28:31], s5 offen offset:0 lds
  v_mfma_f32_32x32x16_bf16 v[208:223], a[112:115], a[228:231], v[208:223]
  s_add_u32 m0, s61, 102336
  ds_read_b128 a[252:255], v148 offset:62464
  buffer_load_dwordx4 v130, s[28:31], s5 offen offset:64 lds
  v_add_f32 v86, v87, v87
  s_waitcnt lgkmcnt(6)
  v_mfma_f32_32x32x16_bf16 v[192:207], a[116:119], a[232:235], v[192:207]
  s_waitcnt vmcnt(8) lgkmcnt(0)
  s_barrier
  ds_read_b64_tr_b16 a[192:193], v180 offset:0
  s_add_u32 m0, s61, 106496
  ds_read_b64_tr_b16 a[194:195], v180 offset:256
  buffer_load_dwordx4 v130, s[32:35], s5 offen offset:0 lds
  v_mfma_f32_32x32x16_bf16 v[208:223], a[116:119], a[236:239], v[208:223]
  ds_read_b64_tr_b16 a[196:197], v180 offset:4096
  s_add_u32 m0, s61, 110528
  ds_read_b64_tr_b16 a[198:199], v180 offset:4352
  buffer_load_dwordx4 v130, s[32:35], s5 offen offset:64 lds
  v_mfma_f32_32x32x16_bf16 v[192:207], a[120:123], a[240:243], v[192:207]
  ds_read_b64_tr_b16 a[200:201], v180 offset:8192
  ds_read_b64_tr_b16 a[202:203], v180 offset:8448
  v_fma_f32 v85, -v88, v88, v85
  v_mul_f32 v86, v86, v88
  v_cmp_eq_u32 vcc, 0, v37
  s_nop 1
  v_cndmask_b32 v27, v85, 1.0, vcc
  v_cndmask_b32 v28, v86, 0, vcc
  v_mfma_f32_32x32x16_bf16 v[208:223], a[120:123], a[244:247], v[208:223]
  ds_read_b64_tr_b16 a[204:205], v180 offset:12288
  ds_read_b64_tr_b16 a[206:207], v180 offset:12544
  v_mfma_f32_32x32x16_bf16 v[192:207], a[124:127], a[248:251], v[192:207]
  ds_read_b64_tr_b16 a[208:209], v180 offset:1024
  ds_read_b64_tr_b16 a[210:211], v180 offset:1280
  v_mfma_f32_32x32x16_bf16 v[208:223], a[124:127], a[252:255], v[208:223]
  ds_read_b64_tr_b16 a[212:213], v180 offset:5120
  ds_read_b64_tr_b16 a[214:215], v180 offset:5376
  s_add_u32 m0, s61, 114688
  s_xor_b32 s5, s0, 3
  s_mul_i32 s5, s5, 229376
  buffer_load_dwordx4 v130, s[28:31], s5 offen offset:0 lds
  s_waitcnt lgkmcnt(8)
  v_mfma_f32_32x32x16_bf16 v[64:79], a[192:195], a[0:3], 0
  ds_read_b64_tr_b16 a[216:217], v180 offset:9216
  ds_read_b64_tr_b16 a[218:219], v180 offset:9472
  v_mfma_f32_32x32x16_bf16 v[80:95], a[196:199], a[0:3], 0
  ds_read_b64_tr_b16 a[220:221], v180 offset:13312
  ds_read_b64_tr_b16 a[222:223], v180 offset:13568
  v_fma_f32 v226, v192, v18, v193
  v_fma_f32 v227, v192, v19, v209
  v_fma_f32 v226, -v208, v19, v226
  v_fmac_f32 v227, v208, v18
  v_fma_f32 v228, v226, v18, v194
  v_fma_f32 v229, v226, v19, v210
  s_waitcnt lgkmcnt(8)
  v_mfma_f32_32x32x16_bf16 v[96:111], a[200:203], a[0:3], 0
  ds_read_b64_tr_b16 a[224:225], v180 offset:2048
  s_add_u32 m0, s61, 118720
  ds_read_b64_tr_b16 a[226:227], v180 offset:2304
  buffer_load_dwordx4 v130, s[28:31], s5 offen offset:64 lds
  v_mfma_f32_32x32x16_bf16 v[112:127], a[204:207], a[0:3], 0
  ds_read_b64_tr_b16 a[228:229], v180 offset:6144
  ds_read_b64_tr_b16 a[230:231], v180 offset:6400
  v_fma_f32 v228, -v227, v19, v228
  v_fmac_f32 v229, v227, v18
  v_fma_f32 v226, v228, v18, v195
  v_fma_f32 v227, v228, v19, v211
  v_fma_f32 v226, -v229, v19, v226
  v_fmac_f32 v227, v229, v18
  s_waitcnt lgkmcnt(8)
  v_mfma_f32_32x32x16_bf16 v[64:79], a[208:211], a[4:7], v[64:79]
  ds_read_b64_tr_b16 a[232:233], v180 offset:10240
  ds_read_b64_tr_b16 a[234:235], v180 offset:10496
  v_fma_f32 v228, v226, v18, v196
  v_fma_f32 v229, v226, v19, v212
  v_fma_f32 v228, -v227, v19, v228
  v_fmac_f32 v229, v227, v18
  v_fma_f32 v226, v228, v18, v197
  v_fma_f32 v227, v228, v19, v213
  v_mfma_f32_32x32x16_bf16 v[80:95], a[212:215], a[4:7], v[80:95]
  ds_read_b64_tr_b16 a[236:237], v180 offset:14336
  s_add_u32 m0, s61, 122880
  ds_read_b64_tr_b16 a[238:239], v180 offset:14592
  buffer_load_dwordx4 v130, s[32:35], s5 offen offset:0 lds
  buffer_load_dword v13, v16, s[52:55], 0 offen sc1
  s_lshl_b32 s6, s2, 2
  s_add_u32 s6, s6, s56
  s_mov_b32 s19, 0x20000
  s_mov_b32 s16, s36
  s_mov_b32 s17, s37
  s_mov_b32 s18, 1835008
  s_mov_b32 s4, 0
  s_cmp_ge_u32 s6, 448
  s_cselect_b32 s16, s20, s16
  s_cselect_b32 s17, s21, s17
  s_cselect_b32 s18, 524288, s18
  s_cselect_b32 s4, 448, s4
  s_cmp_ge_u32 s6, 576
  s_cselect_b32 s16, s24, s16
  s_cselect_b32 s17, s25, s17
  s_cselect_b32 s18, 524288, s18
  s_cselect_b32 s4, 576, s4
  s_sub_u32 s6, s6, s4
  s_mul_i32 s6, s6, 4096
  v_and_b32 v139, 31, v35
  v_lshlrev_b32 v139, 7, v139
  buffer_load_dword v139, v139, s[16:19], s6 offen
  s_waitcnt lgkmcnt(8)
  v_mfma_f32_32x32x16_bf16 v[96:111], a[216:219], a[4:7], v[96:111]
  ds_read_b64_tr_b16 a[240:241], v180 offset:3072
  ds_read_b64_tr_b16 a[242:243], v180 offset:3328
  v_fma_f32 v226, -v229, v19, v226
  v_fmac_f32 v227, v229, v18
  v_fma_f32 v228, v226, v18, v198
  v_fma_f32 v229, v226, v19, v214
  v_fma_f32 v228, -v227, v19, v228
  v_fmac_f32 v229, v227, v18
  v_mfma_f32_32x32x16_bf16 v[112:127], a[220:223], a[4:7], v[112:127]
  ds_read_b64_tr_b16 a[244:245], v180 offset:7168
  ds_read_b64_tr_b16 a[246:247], v180 offset:7424
  v_fma_f32 v226, v228, v18, v199
  v_fma_f32 v227, v228, v19, v215
  v_fma_f32 v226, -v229, v19, v226
  v_fmac_f32 v227, v229, v18
  v_fma_f32 v228, v226, v18, v200
  v_fma_f32 v229, v226, v19, v216
  s_waitcnt lgkmcnt(8)
  v_mfma_f32_32x32x16_bf16 v[64:79], a[224:227], a[8:11], v[64:79]
  ds_read_b64_tr_b16 a[248:249], v180 offset:11264
  s_add_u32 m0, s61, 126912
  ds_read_b64_tr_b16 a[250:251], v180 offset:11520
  buffer_load_dwordx4 v130, s[32:35], s5 offen offset:64 lds
  v_mfma_f32_32x32x16_bf16 v[80:95], a[228:231], a[8:11], v[80:95]
  ds_read_b64_tr_b16 a[252:253], v180 offset:15360
  ds_read_b64_tr_b16 a[254:255], v180 offset:15616
  v_fma_f32 v228, -v227, v19, v228
  v_fmac_f32 v229, v227, v18
  v_fma_f32 v226, v228, v18, v201
  v_fma_f32 v227, v228, v19, v217
  v_fma_f32 v226, -v229, v19, v226
  s_waitcnt lgkmcnt(8)
  v_mfma_f32_32x32x16_bf16 v[96:111], a[232:235], a[8:11], v[96:111]
  s_waitcnt vmcnt(10)
  s_barrier
  ds_read_b64_tr_b16 a[192:193], v180 offset:16384
  ds_read_b64_tr_b16 a[194:195], v180 offset:16640
  v_fmac_f32 v227, v229, v18
  v_fma_f32 v228, v226, v18, v202
  v_fma_f32 v229, v226, v19, v218
  v_mfma_f32_32x32x16_bf16 v[112:127], a[236:239], a[8:11], v[112:127]
  ds_read_b64_tr_b16 a[196:197], v180 offset:20480
  ds_read_b64_tr_b16 a[198:199], v180 offset:20736
  s_add_u32 m0, s61, 131072
  s_xor_b32 s5, s0, 4
  s_mul_i32 s5, s5, 229376
  buffer_load_dwordx4 v130, s[28:31], s5 offen offset:0 lds
  s_waitcnt lgkmcnt(8)
  v_mfma_f32_32x32x16_bf16 v[64:79], a[240:243], a[12:15], v[64:79]
  ds_read_b64_tr_b16 a[200:201], v180 offset:24576
  ds_read_b64_tr_b16 a[202:203], v180 offset:24832
  v_fma_f32 v228, -v227, v19, v228
  v_fmac_f32 v229, v227, v18
  v_fma_f32 v226, v228, v18, v203
  v_fma_f32 v227, v228, v19, v219
  v_fma_f32 v226, -v229, v19, v226
  v_fmac_f32 v227, v229, v18
  v_mfma_f32_32x32x16_bf16 v[80:95], a[244:247], a[12:15], v[80:95]
  ds_read_b64_tr_b16 a[204:205], v180 offset:28672
  ds_read_b64_tr_b16 a[206:207], v180 offset:28928
  v_fma_f32 v228, v226, v18, v204
  v_fma_f32 v229, v226, v19, v220
  v_fma_f32 v228, -v227, v19, v228
  v_fmac_f32 v229, v227, v18
  v_fma_f32 v226, v228, v18, v205
  v_fma_f32 v227, v228, v19, v221
  s_waitcnt lgkmcnt(8)
  v_mfma_f32_32x32x16_bf16 v[96:111], a[248:251], a[12:15], v[96:111]
  ds_read_b64_tr_b16 a[208:209], v180 offset:17408
  s_add_u32 m0, s61, 135104
  ds_read_b64_tr_b16 a[210:211], v180 offset:17664
  buffer_load_dwordx4 v130, s[28:31], s5 offen offset:64 lds
  v_mfma_f32_32x32x16_bf16 v[112:127], a[252:255], a[12:15], v[112:127]
  ds_read_b64_tr_b16 a[212:213], v180 offset:21504
  ds_read_b64_tr_b16 a[214:215], v180 offset:21760
  v_fma_f32 v226, -v229, v19, v226
  v_fmac_f32 v227, v229, v18
  v_fma_f32 v228, v226, v18, v206
  v_fma_f32 v229, v226, v19, v222
  v_fma_f32 v228, -v227, v19, v228
  v_fmac_f32 v229, v227, v18
  s_waitcnt lgkmcnt(8)
  v_mfma_f32_32x32x16_bf16 v[64:79], a[192:195], a[16:19], v[64:79]
  ds_read_b64_tr_b16 a[216:217], v180 offset:25600
  ds_read_b64_tr_b16 a[218:219], v180 offset:25856
  v_fma_f32 v226, v228, v18, v207
  v_fma_f32 v227, v228, v19, v223
  v_fma_f32 v226, -v229, v19, v226
  v_fmac_f32 v227, v229, v18
  ds_write_b64 v137, v[226:227]
  v_mfma_f32_32x32x16_bf16 v[80:95], a[196:199], a[16:19], v[80:95]
  ds_read_b64_tr_b16 a[220:221], v180 offset:29696
  s_add_u32 m0, s61, 139264
  ds_read_b64_tr_b16 a[222:223], v180 offset:29952
  buffer_load_dwordx4 v130, s[32:35], s5 offen offset:0 lds
  s_waitcnt lgkmcnt(9)
  v_mfma_f32_32x32x16_bf16 v[96:111], a[200:203], a[16:19], v[96:111]
  s_waitcnt lgkmcnt(2)
  s_barrier
  ds_read_b64_tr_b16 a[224:225], v180 offset:18432
  ds_read_b64_tr_b16 a[226:227], v180 offset:18688
  v_mfma_f32_32x32x16_bf16 v[112:127], a[204:207], a[16:19], v[112:127]
  ds_read_b64_tr_b16 a[228:229], v180 offset:22528
  ds_read_b64_tr_b16 a[230:231], v180 offset:22784
  ds_read_b64 v[240:241], v15 offset:0
  ds_read_b64 v[242:243], v15 offset:256
  ds_read_b64 v[244:245], v15 offset:512
  ds_read_b64 v[246:247], v15 offset:768
  ds_read_b64 v[248:249], v15 offset:1024
  ds_read_b64 v[250:251], v15 offset:1280
  ds_read_b64 v[252:253], v15 offset:1536
  v_mfma_f32_32x32x16_bf16 v[64:79], a[208:211], a[20:23], v[64:79]
  ds_read_b64_tr_b16 a[232:233], v180 offset:26624
  s_add_u32 m0, s61, 143296
  ds_read_b64_tr_b16 a[234:235], v180 offset:26880
  buffer_load_dwordx4 v130, s[32:35], s5 offen offset:64 lds
  ds_read_b64 v[254:255], v15 offset:1792
  v_mfma_f32_32x32x16_bf16 v[80:95], a[212:215], a[20:23], v[80:95]
  ds_read_b64_tr_b16 a[236:237], v180 offset:30720
  ds_read_b64_tr_b16 a[238:239], v180 offset:30976
  v_mov_b32 v21, 0
  v_mov_b32 v22, 0
  v_cmp_eq_u32 vcc, 1, v135
  s_waitcnt lgkmcnt(11)
  s_nop 0
  v_cndmask_b32 v21, v21, v240, vcc
  v_cndmask_b32 v22, v22, v241, vcc
  s_waitcnt lgkmcnt(10)
  v_fma_f32 v224, v240, v133, v242
  v_fma_f32 v225, v240, v134, v243
  v_fma_f32 v224, -v241, v134, v224
  v_mfma_f32_32x32x16_bf16 v[96:111], a[216:219], a[20:23], v[96:111]
  ds_read_b64_tr_b16 a[240:241], v180 offset:19456
  ds_read_b64_tr_b16 a[242:243], v180 offset:19712
  v_fmac_f32 v225, v241, v133
  v_cmp_eq_u32 vcc, 2, v135
  s_nop 1
  v_cndmask_b32 v21, v21, v224, vcc
  v_cndmask_b32 v22, v22, v225, vcc
  s_waitcnt lgkmcnt(11)
  v_fma_f32 v226, v224, v133, v244
  v_fma_f32 v227, v224, v134, v245
  v_fma_f32 v226, -v225, v134, v226
  v_mfma_f32_32x32x16_bf16 v[112:127], a[220:223], a[20:23], v[112:127]
  ds_read_b64_tr_b16 a[244:245], v180 offset:23552
  ds_read_b64_tr_b16 a[246:247], v180 offset:23808
  s_add_u32 m0, s61, 147456
  s_xor_b32 s5, s0, 5
  s_mul_i32 s5, s5, 229376
  buffer_load_dwordx4 v130, s[28:31], s5 offen offset:0 lds
  v_mfma_f32_32x32x16_bf16 v[64:79], a[224:227], a[24:27], v[64:79]
  ds_read_b64_tr_b16 a[248:249], v180 offset:27648
  ds_read_b64_tr_b16 a[250:251], v180 offset:27904
  v_fmac_f32 v227, v225, v133
  v_cmp_eq_u32 vcc, 3, v135
  s_nop 1
  v_cndmask_b32 v21, v21, v226, vcc
  v_cndmask_b32 v22, v22, v227, vcc
  s_waitcnt lgkmcnt(14)
  v_fma_f32 v224, v226, v133, v246
  v_fma_f32 v225, v226, v134, v247
  v_fma_f32 v224, -v227, v134, v224
  v_mfma_f32_32x32x16_bf16 v[80:95], a[228:231], a[24:27], v[80:95]
  ds_read_b64_tr_b16 a[252:253], v180 offset:31744
  ds_read_b64_tr_b16 a[254:255], v180 offset:32000
  v_fmac_f32 v225, v227, v133
  v_cmp_eq_u32 vcc, 4, v135
  s_nop 1
  v_cndmask_b32 v21, v21, v224, vcc
  v_cndmask_b32 v22, v22, v225, vcc
  s_waitcnt lgkmcnt(15)
  v_fma_f32 v226, v224, v133, v248
  v_fma_f32 v227, v224, v134, v249
  v_fma_f32 v226, -v225, v134, v226
  s_waitcnt lgkmcnt(8)
  v_mfma_f32_32x32x16_bf16 v[96:111], a[232:235], a[24:27], v[96:111]
  s_waitcnt vmcnt(11)
  s_barrier
  ds_read_b64_tr_b16 a[192:193], v180 offset:32768
  s_add_u32 m0, s61, 151488
  ds_read_b64_tr_b16 a[194:195], v180 offset:33024
  buffer_load_dwordx4 v130, s[28:31], s5 offen offset:64 lds
  v_mfma_f32_32x32x16_bf16 v[112:127], a[236:239], a[24:27], v[112:127]
  ds_read_b64_tr_b16 a[196:197], v180 offset:36864
  ds_read_b64_tr_b16 a[198:199], v180 offset:37120
  v_fmac_f32 v227, v225, v133
  v_cmp_eq_u32 vcc, 5, v135
  s_nop 1
  v_cndmask_b32 v21, v21, v226, vcc
  v_cndmask_b32 v22, v22, v227, vcc
  v_fma_f32 v224, v226, v133, v250
  v_fma_f32 v225, v226, v134, v251
  v_fma_f32 v224, -v227, v134, v224
  v_fmac_f32 v225, v227, v133
  s_waitcnt lgkmcnt(8)
  v_mfma_f32_32x32x16_bf16 v[64:79], a[240:243], a[28:31], v[64:79]
  ds_read_b64_tr_b16 a[200:201], v180 offset:40960
  ds_read_b64_tr_b16 a[202:203], v180 offset:41216
  v_cmp_eq_u32 vcc, 6, v135
  s_nop 1
  v_cndmask_b32 v21, v21, v224, vcc
  v_cndmask_b32 v22, v22, v225, vcc
  v_fma_f32 v226, v224, v133, v252
  v_fma_f32 v227, v224, v134, v253
  v_fma_f32 v226, -v225, v134, v226
  v_fmac_f32 v227, v225, v133
  v_mfma_f32_32x32x16_bf16 v[80:95], a[244:247], a[28:31], v[80:95]
  ds_read_b64_tr_b16 a[204:205], v180 offset:45056
  s_add_u32 m0, s61, 155648
  ds_read_b64_tr_b16 a[206:207], v180 offset:45312
  buffer_load_dwordx4 v130, s[32:35], s5 offen offset:0 lds
  s_waitcnt lgkmcnt(8)
  v_mfma_f32_32x32x16_bf16 v[96:111], a[248:251], a[28:31], v[96:111]
  ds_read_b64_tr_b16 a[208:209], v180 offset:33792
  ds_read_b64_tr_b16 a[210:211], v180 offset:34048
  v_cmp_eq_u32 vcc, 7, v135
  s_nop 1
  v_cndmask_b32 v21, v21, v226, vcc
  v_cndmask_b32 v22, v22, v227, vcc
  v_fma_f32 v224, v226, v133, v254
  v_fma_f32 v225, v226, v134, v255
  v_fma_f32 v224, -v227, v134, v224
  v_fmac_f32 v225, v227, v133
  v_mfma_f32_32x32x16_bf16 v[112:127], a[252:255], a[28:31], v[112:127]
  ds_read_b64_tr_b16 a[212:213], v180 offset:37888
  ds_read_b64_tr_b16 a[214:215], v180 offset:38144
  s_waitcnt vmcnt(9)
  v_cmp_gt_u32 vcc, 1, v13
  s_nop 0
  s_cbranch_vccz SPD0
  s_mov_b32 s6, 0
SP0:
  buffer_load_dword v13, v16, s[52:55], 0 offen sc1
  s_add_u32 s6, s6, 1
  s_waitcnt vmcnt(0)
  s_cmp_gt_u32 s6, 300000
  s_cbranch_scc1 SPD0
  v_cmp_gt_u32 vcc, 1, v13
  s_nop 0
  s_cbranch_vccnz SP0
SPD0:
  buffer_store_dwordx2 v[224:225], v11, s[48:51], 0 offen sc1
  s_waitcnt lgkmcnt(8)
  v_mfma_f32_32x32x16_bf16 v[64:79], a[192:195], a[32:35], v[64:79]
  ds_read_b64_tr_b16 a[216:217], v180 offset:41984
  s_add_u32 m0, s61, 159680
  ds_read_b64_tr_b16 a[218:219], v180 offset:42240
  buffer_load_dwordx4 v130, s[32:35], s5 offen offset:64 lds
  v_mfma_f32_32x32x16_bf16 v[80:95], a[196:199], a[32:35], v[80:95]
  ds_read_b64_tr_b16 a[220:221], v180 offset:46080
  ds_read_b64_tr_b16 a[222:223], v180 offset:46336
  v_mul_f32 v230, v192, v132
  v_mul_f32 v192, v192, v131
  v_fma_f32 v192, -v208, v132, v192
  v_fma_f32 v208, v208, v131, v230
  s_waitcnt lgkmcnt(8)
  v_mfma_f32_32x32x16_bf16 v[96:111], a[200:203], a[32:35], v[96:111]
  ds_read_b64_tr_b16 a[224:225], v180 offset:34816
  ds_read_b64_tr_b16 a[226:227], v180 offset:35072
  v_mul_f32 v231, v193, v132
  v_mul_f32 v193, v193, v131
  v_fma_f32 v193, -v209, v132, v193
  v_fma_f32 v209, v209, v131, v231
  v_mfma_f32_32x32x16_bf16 v[112:127], a[204:207], a[32:35], v[112:127]
  ds_read_b64_tr_b16 a[228:229], v180 offset:38912
  ds_read_b64_tr_b16 a[230:231], v180 offset:39168
  s_add_u32 m0, s61, 16384
  s_xor_b32 s5, s0, 6
  s_mul_i32 s5, s5, 229376
  buffer_load_dwordx4 v130, s[28:31], s5 offen offset:0 lds
  s_waitcnt lgkmcnt(8)
  v_mfma_f32_32x32x16_bf16 v[64:79], a[208:211], a[36:39], v[64:79]
  ds_read_b64_tr_b16 a[232:233], v180 offset:43008
  ds_read_b64_tr_b16 a[234:235], v180 offset:43264
  v_mul_f32 v230, v194, v132
  v_mul_f32 v194, v194, v131
  v_fma_f32 v194, -v210, v132, v194
  v_fma_f32 v210, v210, v131, v230
  v_mfma_f32_32x32x16_bf16 v[80:95], a[212:215], a[36:39], v[80:95]
  ds_read_b64_tr_b16 a[236:237], v180 offset:47104
  ds_read_b64_tr_b16 a[238:239], v180 offset:47360
  v_mul_f32 v231, v195, v132
  v_mul_f32 v195, v195, v131
  v_fma_f32 v195, -v211, v132, v195
  v_fma_f32 v211, v211, v131, v231
  s_waitcnt lgkmcnt(8)
  v_mfma_f32_32x32x16_bf16 v[96:111], a[216:219], a[36:39], v[96:111]
  ds_read_b64_tr_b16 a[240:241], v180 offset:35840
  s_add_u32 m0, s61, 20416
  ds_read_b64_tr_b16 a[242:243], v180 offset:36096
  buffer_load_dwordx4 v130, s[28:31], s5 offen offset:64 lds
  v_mfma_f32_32x32x16_bf16 v[112:127], a[220:223], a[36:39], v[112:127]
  ds_read_b64_tr_b16 a[244:245], v180 offset:39936
  ds_read_b64_tr_b16 a[246:247], v180 offset:40192
  v_mul_f32 v230, v196, v132
  v_mul_f32 v196, v196, v131
  v_fma_f32 v196, -v212, v132, v196
  v_fma_f32 v212, v212, v131, v230
  v_mul_f32 v231, v197, v132
  v_mov_b32 v232, -1
  s_waitcnt lgkmcnt(8)
  v_mfma_f32_32x32x16_bf16 v[64:79], a[224:227], a[40:43], v[64:79]
  ds_read_b64_tr_b16 a[248:249], v180 offset:44032
  ds_read_b64_tr_b16 a[250:251], v180 offset:44288
  v_mul_f32 v197, v197, v131
  v_fma_f32 v197, -v213, v132, v197
  v_fma_f32 v213, v213, v131, v231
  v_mul_f32 v230, v198, v132
  v_mov_b32 v233, -1
  v_mov_b32 v234, -1
  v_mov_b32 v235, -1
  v_mfma_f32_32x32x16_bf16 v[80:95], a[228:231], a[40:43], v[80:95]
  ds_read_b64_tr_b16 a[252:253], v180 offset:48128
  s_add_u32 m0, s61, 24576
  ds_read_b64_tr_b16 a[254:255], v180 offset:48384
  buffer_load_dwordx4 v130, s[32:35], s5 offen offset:0 lds
  s_waitcnt lgkmcnt(8)
  v_mfma_f32_32x32x16_bf16 v[96:111], a[232:235], a[40:43], v[96:111]
  s_waitcnt vmcnt(12)
  s_barrier
  ds_read_b64_tr_b16 a[192:193], v180 offset:49152
  ds_read_b64_tr_b16 a[194:195], v180 offset:49408
  v_mul_f32 v198, v198, v131
  v_mfma_f32_32x32x16_bf16 v[112:127], a[236:239], a[40:43], v[112:127]
  ds_read_b64_tr_b16 a[196:197], v180 offset:53248
  ds_read_b64_tr_b16 a[198:199], v180 offset:53504
  v_fma_f32 v198, -v214, v132, v198
  v_fma_f32 v214, v214, v131, v230
  v_mul_f32 v231, v199, v132
  v_mul_f32 v199, v199, v131
  buffer_store_dwordx4 v[232:235], v41, s[44:47], 0 offen offset:0 sc1
  s_waitcnt lgkmcnt(8)
  v_mfma_f32_32x32x16_bf16 v[64:79], a[240:243], a[44:47], v[64:79]
  ds_read_b64_tr_b16 a[200:201], v180 offset:57344
  s_add_u32 m0, s61, 28608
  ds_read_b64_tr_b16 a[202:203], v180 offset:57600
  buffer_load_dwordx4 v130, s[32:35], s5 offen offset:64 lds
  v_mfma_f32_32x32x16_bf16 v[80:95], a[244:247], a[44:47], v[80:95]
  ds_read_b64_tr_b16 a[204:205], v180 offset:61440
  ds_read_b64_tr_b16 a[206:207], v180 offset:61696
  v_fma_f32 v199, -v215, v132, v199
  v_fma_f32 v215, v215, v131, v231
  v_mul_f32 v230, v200, v132
  v_mul_f32 v200, v200, v131
  s_waitcnt lgkmcnt(8)
  v_mfma_f32_32x32x16_bf16 v[96:111], a[248:251], a[44:47], v[96:111]
  ds_read_b64_tr_b16 a[208:209], v180 offset:50176
  ds_read_b64_tr_b16 a[210:211], v180 offset:50432
  v_fma_f32 v200, -v216, v132, v200
  v_fma_f32 v216, v216, v131, v230
  v_mul_f32 v231, v201, v132
  v_mul_f32 v201, v201, v131
  buffer_store_dwordx4 v[232:235], v41, s[44:47], 0 offen offset:1024 sc1
  v_mfma_f32_32x32x16_bf16 v[112:127], a[252:255], a[44:47], v[112:127]
  ds_read_b64_tr_b16 a[212:213], v180 offset:54272
  ds_read_b64_tr_b16 a[214:215], v180 offset:54528
  s_add_u32 m0, s61, 32768
  s_xor_b32 s5, s0, 7
  s_mul_i32 s5, s5, 229376
  buffer_load_dwordx4 v130, s[28:31], s5 offen offset:0 lds
  s_waitcnt lgkmcnt(8)
  v_mfma_f32_32x32x16_bf16 v[64:79], a[192:195], a[48:51], v[64:79]
  ds_read_b64_tr_b16 a[216:217], v180 offset:58368
  ds_read_b64_tr_b16 a[218:219], v180 offset:58624
  v_fma_f32 v201, -v217, v132, v201
  v_fma_f32 v217, v217, v131, v231
  v_mul_f32 v230, v202, v132
  v_mul_f32 v202, v202, v131
  v_mfma_f32_32x32x16_bf16 v[80:95], a[196:199], a[48:51], v[80:95]
  ds_read_b64_tr_b16 a[220:221], v180 offset:62464
  ds_read_b64_tr_b16 a[222:223], v180 offset:62720
  v_fma_f32 v202, -v218, v132, v202
  v_fma_f32 v218, v218, v131, v230
  v_mul_f32 v231, v203, v132
  v_mul_f32 v203, v203, v131
  buffer_store_dwordx4 v[232:235], v41, s[44:47], 0 offen offset:2048 sc1
  s_waitcnt lgkmcnt(8)
  v_mfma_f32_32x32x16_bf16 v[96:111], a[200:203], a[48:51], v[96:111]
  ds_read_b64_tr_b16 a[224:225], v180 offset:51200
  s_add_u32 m0, s61, 36800
  ds_read_b64_tr_b16 a[226:227], v180 offset:51456
  buffer_load_dwordx4 v130, s[28:31], s5 offen offset:64 lds
  v_mfma_f32_32x32x16_bf16 v[112:127], a[204:207], a[48:51], v[112:127]
  ds_read_b64_tr_b16 a[228:229], v180 offset:55296
  ds_read_b64_tr_b16 a[230:231], v180 offset:55552
  v_fma_f32 v203, -v219, v132, v203
  v_fma_f32 v219, v219, v131, v231
  v_mul_f32 v230, v204, v132
  v_mul_f32 v204, v204, v131
  s_waitcnt lgkmcnt(8)
  v_mfma_f32_32x32x16_bf16 v[64:79], a[208:211], a[52:55], v[64:79]
  ds_read_b64_tr_b16 a[232:233], v180 offset:59392
  ds_read_b64_tr_b16 a[234:235], v180 offset:59648
  v_fma_f32 v204, -v220, v132, v204
  v_fma_f32 v220, v220, v131, v230
  v_mul_f32 v231, v205, v132
  v_mul_f32 v205, v205, v131
  v_mfma_f32_32x32x16_bf16 v[80:95], a[212:215], a[52:55], v[80:95]
  ds_read_b64_tr_b16 a[236:237], v180 offset:63488
  s_add_u32 m0, s61, 40960
  ds_read_b64_tr_b16 a[238:239], v180 offset:63744
  buffer_load_dwordx4 v130, s[32:35], s5 offen offset:0 lds
  s_waitcnt lgkmcnt(8)
  v_mfma_f32_32x32x16_bf16 v[96:111], a[216:219], a[52:55], v[96:111]
  ds_read_b64_tr_b16 a[240:241], v180 offset:52224
  ds_read_b64_tr_b16 a[242:243], v180 offset:52480
  v_fma_f32 v205, -v221, v132, v205
  v_fma_f32 v221, v221, v131, v231
  v_mul_f32 v230, v206, v132
  v_mul_f32 v206, v206, v131
  v_fma_f32 v206, -v222, v132, v206
  buffer_store_dwordx4 v[232:235], v41, s[44:47], 0 offen offset:3072 sc1
  v_mfma_f32_32x32x16_bf16 v[112:127], a[220:223], a[52:55], v[112:127]
  ds_read_b64_tr_b16 a[244:245], v180 offset:56320
  ds_read_b64_tr_b16 a[246:247], v180 offset:56576
  v_fma_f32 v222, v222, v131, v230
  v_mul_f32 v231, v207, v132
  v_mul_f32 v207, v207, v131
  v_fma_f32 v207, -v223, v132, v207
  s_waitcnt lgkmcnt(8)
  v_mfma_f32_32x32x16_bf16 v[64:79], a[224:227], a[56:59], v[64:79]
  ds_read_b64_tr_b16 a[248:249], v180 offset:60416
  s_add_u32 m0, s61, 44992
  ds_read_b64_tr_b16 a[250:251], v180 offset:60672
  buffer_load_dwordx4 v130, s[32:35], s5 offen offset:64 lds
  v_mfma_f32_32x32x16_bf16 v[80:95], a[228:231], a[56:59], v[80:95]
  ds_read_b64_tr_b16 a[252:253], v180 offset:64512
  ds_read_b64_tr_b16 a[254:255], v180 offset:64768
  v_fma_f32 v223, v223, v131, v231
  v_mul_f32 v228, v21, v131
  v_mul_f32 v229, v21, v132
  v_fma_f32 v228, -v22, v132, v228
  buffer_store_dwordx4 v[232:235], v41, s[44:47], s7 offen offset:0 sc1
  s_waitcnt lgkmcnt(8)
  v_mfma_f32_32x32x16_bf16 v[96:111], a[232:235], a[56:59], v[96:111]
  s_waitcnt vmcnt(18)
  s_barrier
  ds_read_b64_tr_b16 a[192:193], v181 offset:0
  ds_read_b64_tr_b16 a[194:195], v181 offset:256
  v_fmac_f32 v229, v22, v131
  v_mfma_f32_32x32x16_bf16 v[112:127], a[236:239], a[56:59], v[112:127]
  ds_read_b64_tr_b16 a[196:197], v181 offset:4096
  ds_read_b64_tr_b16 a[198:199], v181 offset:4352
  s_add_u32 m0, s61, 49152
  s_lshr_b32 s5, s0, 1
  s_xor_b32 s5, s5, 0
  s_mul_i32 s5, s5, 458752
  buffer_load_dwordx4 v176, s[28:31], s5 offen offset:0 lds
  s_waitcnt lgkmcnt(8)
  v_mfma_f32_32x32x16_bf16 v[64:79], a[240:243], a[60:63], v[64:79]
  ds_read_b64_tr_b16 a[200:201], v181 offset:8192
  ds_read_b64_tr_b16 a[202:203], v181 offset:8448
  v_mul_f32 v230, v23, v131
  v_mul_f32 v231, v23, v132
  v_fma_f32 v230, -v24, v132, v230
  v_fmac_f32 v231, v24, v131
  v_mfma_f32_32x32x16_bf16 v[80:95], a[244:247], a[60:63], v[80:95]
  ds_read_b64_tr_b16 a[204:205], v181 offset:12288
  ds_read_b64_tr_b16 a[206:207], v181 offset:12544
  v_mov_b32 v21, v228
  v_mov_b32 v22, v229
  v_mov_b32 v23, v230
  v_mov_b32 v24, v231
  buffer_store_dwordx4 v[232:235], v41, s[44:47], s7 offen offset:1024 sc1
  s_waitcnt lgkmcnt(8)
  v_mfma_f32_32x32x16_bf16 v[96:111], a[248:251], a[60:63], v[96:111]
  ds_read_b64_tr_b16 a[208:209], v181 offset:1024
  s_add_u32 m0, s61, 65536
  ds_read_b64_tr_b16 a[210:211], v181 offset:1280
  buffer_load_dwordx4 v177, s[28:31], s5 offen offset:0 lds
  v_mfma_f32_32x32x16_bf16 v[112:127], a[252:255], a[60:63], v[112:127]
  ds_read_b64_tr_b16 a[212:213], v181 offset:5120
  ds_read_b64_tr_b16 a[214:215], v181 offset:5376
  buffer_store_dwordx4 v[232:235], v41, s[44:47], s7 offen offset:2048 sc1
  s_waitcnt lgkmcnt(8)
  v_mfma_f32_32x32x16_bf16 v[64:79], a[192:195], a[64:67], v[64:79]
  ds_read_b64_tr_b16 a[216:217], v181 offset:9216
  ds_read_b64_tr_b16 a[218:219], v181 offset:9472
  buffer_store_dwordx4 v[232:235], v41, s[44:47], s7 offen offset:3072 sc1
  v_mfma_f32_32x32x16_bf16 v[80:95], a[196:199], a[64:67], v[80:95]
  ds_read_b64_tr_b16 a[220:221], v181 offset:13312
  s_add_u32 m0, s61, 57344
  ds_read_b64_tr_b16 a[222:223], v181 offset:13568
  buffer_load_dwordx4 v179, s[28:31], s5 offen offset:0 lds
  s_waitcnt lgkmcnt(8)
  v_mfma_f32_32x32x16_bf16 v[96:111], a[200:203], a[64:67], v[96:111]
  ds_read_b64_tr_b16 a[224:225], v181 offset:2048
  ds_read_b64_tr_b16 a[226:227], v181 offset:2304
  v_mfma_f32_32x32x16_bf16 v[112:127], a[204:207], a[64:67], v[112:127]
  ds_read_b64_tr_b16 a[228:229], v181 offset:6144
  ds_read_b64_tr_b16 a[230:231], v181 offset:6400
  buffer_load_dwordx2 v[240:241], v12, s[48:51], 0 offen offset:0 sc1
  buffer_load_dwordx2 v[242:243], v12, s[48:51], 0 offen offset:256 sc1
  s_waitcnt lgkmcnt(8)
  v_mfma_f32_32x32x16_bf16 v[64:79], a[208:211], a[68:71], v[64:79]
  ds_read_b64_tr_b16 a[232:233], v181 offset:10240
  s_add_u32 m0, s61, 53248
  ds_read_b64_tr_b16 a[234:235], v181 offset:10496
  buffer_load_dwordx4 v176, s[32:35], s5 offen offset:0 lds
  buffer_load_dwordx2 v[244:245], v12, s[48:51], 0 offen offset:512 sc1
  buffer_load_dwordx2 v[246:247], v12, s[48:51], 0 offen offset:768 sc1
  v_mfma_f32_32x32x16_bf16 v[80:95], a[212:215], a[68:71], v[80:95]
  ds_read_b64_tr_b16 a[236:237], v181 offset:14336
  ds_read_b64_tr_b16 a[238:239], v181 offset:14592
  buffer_load_dwordx2 v[248:249], v12, s[48:51], 0 offen offset:1024 sc1
  buffer_load_dwordx2 v[250:251], v12, s[48:51], 0 offen offset:1280 sc1
  s_waitcnt lgkmcnt(8)
  v_mfma_f32_32x32x16_bf16 v[96:111], a[216:219], a[68:71], v[96:111]
  ds_read_b64_tr_b16 a[240:241], v181 offset:3072
  ds_read_b64_tr_b16 a[242:243], v181 offset:3328
  buffer_load_dwordx2 v[252:253], v12, s[48:51], 0 offen offset:1536 sc1
  buffer_load_dwordx2 v[254:255], v12, s[48:51], 0 offen offset:1792 sc1
  v_mfma_f32_32x32x16_bf16 v[112:127], a[220:223], a[68:71], v[112:127]
  ds_read_b64_tr_b16 a[244:245], v181 offset:7168
  s_add_u32 m0, s61, 69632
  ds_read_b64_tr_b16 a[246:247], v181 offset:7424
  buffer_load_dwordx4 v178, s[32:35], s5 offen offset:0 lds
  s_waitcnt lgkmcnt(8)
  v_mfma_f32_32x32x16_bf16 v[64:79], a[224:227], a[72:75], v[64:79]
  ds_read_b64_tr_b16 a[248:249], v181 offset:11264
  ds_read_b64_tr_b16 a[250:251], v181 offset:11520
  v_mfma_f32_32x32x16_bf16 v[80:95], a[228:231], a[72:75], v[80:95]
  ds_read_b64_tr_b16 a[252:253], v181 offset:15360
  ds_read_b64_tr_b16 a[254:255], v181 offset:15616
  s_waitcnt lgkmcnt(8)
  v_mfma_f32_32x32x16_bf16 v[96:111], a[232:235], a[72:75], v[96:111]
  s_waitcnt vmcnt(29)
  s_barrier
  ds_read_b64_tr_b16 a[192:193], v181 offset:16384
  s_add_u32 m0, s61, 61440
  ds_read_b64_tr_b16 a[194:195], v181 offset:16640
  buffer_load_dwordx4 v179, s[32:35], s5 offen offset:0 lds
  v_mfma_f32_32x32x16_bf16 v[112:127], a[236:239], a[72:75], v[112:127]
  ds_read_b64_tr_b16 a[196:197], v181 offset:20480
  ds_read_b64_tr_b16 a[198:199], v181 offset:20736
  s_waitcnt lgkmcnt(8)
  v_mfma_f32_32x32x16_bf16 v[64:79], a[240:243], a[76:79], v[64:79]
  ds_read_b64_tr_b16 a[200:201], v181 offset:24576
  ds_read_b64_tr_b16 a[202:203], v181 offset:24832
  v_mfma_f32_32x32x16_bf16 v[80:95], a[244:247], a[76:79], v[80:95]
  ds_read_b64_tr_b16 a[204:205], v181 offset:28672
  ds_read_b64_tr_b16 a[206:207], v181 offset:28928
  s_add_u32 m0, s61, 73728
  s_lshr_b32 s5, s0, 1
  s_xor_b32 s5, s5, 1
  s_mul_i32 s5, s5, 458752
  buffer_load_dwordx4 v176, s[28:31], s5 offen offset:0 lds
  s_waitcnt lgkmcnt(8)
  v_mfma_f32_32x32x16_bf16 v[96:111], a[248:251], a[76:79], v[96:111]
  ds_read_b64_tr_b16 a[208:209], v181 offset:17408
  ds_read_b64_tr_b16 a[210:211], v181 offset:17664
  v_mfma_f32_32x32x16_bf16 v[112:127], a[252:255], a[76:79], v[112:127]
  ds_read_b64_tr_b16 a[212:213], v181 offset:21504
  ds_read_b64_tr_b16 a[214:215], v181 offset:21760
  s_waitcnt lgkmcnt(8)
  v_mfma_f32_32x32x16_bf16 v[64:79], a[192:195], a[80:83], v[64:79]
  ds_read_b64_tr_b16 a[216:217], v181 offset:25600
  s_add_u32 m0, s61, 90112
  ds_read_b64_tr_b16 a[218:219], v181 offset:25856
  buffer_load_dwordx4 v177, s[28:31], s5 offen offset:0 lds
  v_mfma_f32_32x32x16_bf16 v[80:95], a[196:199], a[80:83], v[80:95]
  ds_read_b64_tr_b16 a[220:221], v181 offset:29696
  ds_read_b64_tr_b16 a[222:223], v181 offset:29952
  s_waitcnt lgkmcnt(8)
  v_mfma_f32_32x32x16_bf16 v[96:111], a[200:203], a[80:83], v[96:111]
  ds_read_b64_tr_b16 a[224:225], v181 offset:18432
  ds_read_b64_tr_b16 a[226:227], v181 offset:18688
  v_mfma_f32_32x32x16_bf16 v[112:127], a[204:207], a[80:83], v[112:127]
  ds_read_b64_tr_b16 a[228:229], v181 offset:22528
  s_add_u32 m0, s61, 81920
  ds_read_b64_tr_b16 a[230:231], v181 offset:22784
  buffer_load_dwordx4 v179, s[28:31], s5 offen offset:0 lds
  s_waitcnt lgkmcnt(8)
  v_mfma_f32_32x32x16_bf16 v[64:79], a[208:211], a[84:87], v[64:79]
  ds_read_b64_tr_b16 a[232:233], v181 offset:26624
  ds_read_b64_tr_b16 a[234:235], v181 offset:26880
  v_mfma_f32_32x32x16_bf16 v[80:95], a[212:215], a[84:87], v[80:95]
  ds_read_b64_tr_b16 a[236:237], v181 offset:30720
  ds_read_b64_tr_b16 a[238:239], v181 offset:30976
  s_waitcnt lgkmcnt(8)
  v_mfma_f32_32x32x16_bf16 v[96:111], a[216:219], a[84:87], v[96:111]
  ds_read_b64_tr_b16 a[240:241], v181 offset:19456
  s_add_u32 m0, s61, 77824
  ds_read_b64_tr_b16 a[242:243], v181 offset:19712
  buffer_load_dwordx4 v176, s[32:35], s5 offen offset:0 lds
  v_mfma_f32_32x32x16_bf16 v[112:127], a[220:223], a[84:87], v[112:127]
  ds_read_b64_tr_b16 a[244:245], v181 offset:23552
  ds_read_b64_tr_b16 a[246:247], v181 offset:23808
  s_waitcnt vmcnt(13)
  v_max3_u32 v13, v240, v241, v242
  s_waitcnt vmcnt(11)
  v_max3_u32 v13, v13, v243, v244
  s_waitcnt vmcnt(10)
  v_max3_u32 v13, v13, v245, v246
  s_waitcnt vmcnt(9)
  v_max3_u32 v13, v13, v247, v248
  s_waitcnt vmcnt(8)
  v_max3_u32 v13, v13, v249, v250
  s_waitcnt vmcnt(7)
  v_max3_u32 v13, v13, v251, v252
  s_waitcnt lgkmcnt(8)
  v_mfma_f32_32x32x16_bf16 v[64:79], a[224:227], a[88:91], v[64:79]
  ds_read_b64_tr_b16 a[248:249], v181 offset:27648
  ds_read_b64_tr_b16 a[250:251], v181 offset:27904
  s_waitcnt vmcnt(6)
  v_max3_u32 v13, v13, v253, v254
  v_max3_u32 v13, v13, v255, v255
  v_cmp_eq_u32 vcc, -1, v13
  s_nop 0
  s_cbranch_vccz SPD1
  s_mov_b32 s6, 0
SP1:
  buffer_load_dwordx2 v[240:241], v12, s[48:51], 0 offen offset:0 sc1
  buffer_load_dwordx2 v[242:243], v12, s[48:51], 0 offen offset:256 sc1
  buffer_load_dwordx2 v[244:245], v12, s[48:51], 0 offen offset:512 sc1
  buffer_load_dwordx2 v[246:247], v12, s[48:51], 0 offen offset:768 sc1
  buffer_load_dwordx2 v[248:249], v12, s[48:51], 0 offen offset:1024 sc1
  buffer_load_dwordx2 v[250:251], v12, s[48:51], 0 offen offset:1280 sc1
  buffer_load_dwordx2 v[252:253], v12, s[48:51], 0 offen offset:1536 sc1
  buffer_load_dwordx2 v[254:255], v12, s[48:51], 0 offen offset:1792 sc1
  s_add_u32 s6, s6, 1
  s_waitcnt vmcnt(0)
  s_cmp_gt_u32 s6, 300000
  s_cbranch_scc1 SPD1
  v_max3_u32 v13, v240, v241, v242
  v_max3_u32 v13, v13, v243, v244
  v_max3_u32 v13, v13, v245, v246
  v_max3_u32 v13, v13, v247, v248
  v_max3_u32 v13, v13, v249, v250
  v_max3_u32 v13, v13, v251, v252
  v_max3_u32 v13, v13, v253, v254
  v_max3_u32 v13, v13, v255, v255
  v_cmp_eq_u32 vcc, -1, v13
  s_nop 0
  s_cbranch_vccnz SP1
SPD1:
  v_mfma_f32_32x32x16_bf16 v[80:95], a[228:231], a[88:91], v[80:95]
  ds_read_b64_tr_b16 a[252:253], v181 offset:31744
  s_add_u32 m0, s61, 94208
  ds_read_b64_tr_b16 a[254:255], v181 offset:32000
  buffer_load_dwordx4 v178, s[32:35], s5 offen offset:0 lds
  v_fma_f32 v252, v254, v25, v252
  s_waitcnt lgkmcnt(8)
  v_mfma_f32_32x32x16_bf16 v[96:111], a[232:235], a[88:91], v[96:111]
  s_barrier
  ds_read_b64_tr_b16 a[192:193], v182 offset:16384
  ds_read_b64_tr_b16 a[194:195], v182 offset:16640
  v_fma_f32 v253, v254, v26, v253
  v_fma_f32 v252, -v255, v26, v252
  v_fmac_f32 v253, v255, v25
  v_mfma_f32_32x32x16_bf16 v[112:127], a[236:239], a[88:91], v[112:127]
  ds_read_b64_tr_b16 a[196:197], v182 offset:20480
  ds_read_b64_tr_b16 a[198:199], v182 offset:20736
  v_fma_f32 v250, v252, v25, v250
  v_fma_f32 v251, v252, v26, v251
  v_fma_f32 v250, -v253, v26, v250
  v_fmac_f32 v251, v253, v25
  v_fma_f32 v248, v250, v25, v248
  v_fma_f32 v249, v250, v26, v249
  s_waitcnt lgkmcnt(8)
  v_mfma_f32_32x32x16_bf16 v[64:79], a[240:243], a[92:95], v[64:79]
  ds_read_b64_tr_b16 a[200:201], v182 offset:24576
  s_add_u32 m0, s61, 86016
  ds_read_b64_tr_b16 a[202:203], v182 offset:24832
  buffer_load_dwordx4 v179, s[32:35], s5 offen offset:0 lds
  v_fma_f32 v248, -v251, v26, v248
  v_mfma_f32_32x32x16_bf16 v[80:95], a[244:247], a[92:95], v[80:95]
  ds_read_b64_tr_b16 a[204:205], v182 offset:28672
  ds_read_b64_tr_b16 a[206:207], v182 offset:28928
  v_fmac_f32 v249, v251, v25
  v_fma_f32 v246, v248, v25, v246
  v_fma_f32 v247, v248, v26, v247
  v_fma_f32 v246, -v249, v26, v246
  v_fmac_f32 v247, v249, v25
  v_fma_f32 v244, v246, v25, v244
  s_waitcnt lgkmcnt(8)
  v_mfma_f32_32x32x16_bf16 v[96:111], a[248:251], a[92:95], v[96:111]
  ds_read_b64_tr_b16 a[208:209], v182 offset:17408
  ds_read_b64_tr_b16 a[210:211], v182 offset:17664
  v_fma_f32 v245, v246, v26, v245
  v_fma_f32 v244, -v247, v26, v244
  v_fmac_f32 v245, v247, v25
  v_fma_f32 v242, v244, v25, v242
  v_fma_f32 v243, v244, v26, v243
  v_fma_f32 v242, -v245, v26, v242
  v_mfma_f32_32x32x16_bf16 v[112:127], a[252:255], a[92:95], v[112:127]
  ds_read_b64_tr_b16 a[212:213], v182 offset:21504
  ds_read_b64_tr_b16 a[214:215], v182 offset:21760
  v_fmac_f32 v243, v245, v25
  v_fma_f32 v240, v242, v25, v240
  v_fma_f32 v241, v242, v26, v241
  v_fma_f32 v240, -v243, v26, v240
  v_fmac_f32 v241, v243, v25
  v_mul_f32 v242, v240, v27
  v_mul_f32 v243, v240, v28
  s_waitcnt lgkmcnt(8)
  v_mfma_f32_32x32x16_bf16 v[64:79], a[192:195], a[96:99], v[64:79]
  ds_read_b64_tr_b16 a[216:217], v182 offset:25600
  ds_read_b64_tr_b16 a[218:219], v182 offset:25856
  v_fma_f32 v242, -v241, v28, v242
  v_fmac_f32 v243, v241, v27
  v_mov_b32 v240, v242
  v_mov_b32 v241, v243
  s_nop 0
  v_permlane32_swap_b32 v240, v242
  v_permlane32_swap_b32 v241, v243
  v_mfma_f32_32x32x16_bf16 v[80:95], a[196:199], a[96:99], v[80:95]
  ds_read_b64_tr_b16 a[220:221], v182 offset:29696
  ds_read_b64_tr_b16 a[222:223], v182 offset:29952
  v_add_f32 v240, v240, v242
  v_add_f32 v241, v241, v243
  v_fma_f32 v21, v240, v23, v21
  v_fma_f32 v22, v240, v24, v22
  v_fma_f32 v21, -v241, v24, v21
  v_fmac_f32 v22, v241, v23
  s_waitcnt lgkmcnt(8)
  v_mfma_f32_32x32x16_bf16 v[96:111], a[200:203], a[96:99], v[96:111]
  ds_read_b64_tr_b16 a[224:225], v182 offset:18432
  ds_read_b64_tr_b16 a[226:227], v182 offset:18688
  s_add_u32 m0, s61, 98304
  s_lshr_b32 s5, s0, 1
  s_xor_b32 s5, s5, 2
  s_mul_i32 s5, s5, 458752
  buffer_load_dwordx4 v176, s[28:31], s5 offen offset:0 lds
  v_mfma_f32_32x32x16_bf16 v[112:127], a[204:207], a[96:99], v[112:127]
  ds_read_b64_tr_b16 a[228:229], v182 offset:22528
  ds_read_b64_tr_b16 a[230:231], v182 offset:22784
  v_fmac_f32 v192, v18, v21
  v_fmac_f32 v208, v18, v22
  v_fmac_f32 v192, v20, v22
  v_fmac_f32 v208, v19, v21
  v_fmac_f32 v193, v18, v192
  v_fmac_f32 v209, v18, v208
  s_waitcnt lgkmcnt(8)
  v_mfma_f32_32x32x16_bf16 v[64:79], a[208:211], a[100:103], v[64:79]
  ds_read_b64_tr_b16 a[232:233], v182 offset:26624
  ds_read_b64_tr_b16 a[234:235], v182 offset:26880
  v_fmac_f32 v193, v20, v208
  v_fmac_f32 v209, v19, v192
  v_fmac_f32 v194, v18, v193
  v_fmac_f32 v210, v18, v209
  v_fmac_f32 v194, v20, v209
  v_fmac_f32 v210, v19, v193
  v_fmac_f32 v195, v18, v194
  v_mfma_f32_32x32x16_bf16 v[80:95], a[212:215], a[100:103], v[80:95]
  ds_read_b64_tr_b16 a[236:237], v182 offset:30720
  s_add_u32 m0, s61, 114688
  ds_read_b64_tr_b16 a[238:239], v182 offset:30976
  buffer_load_dwordx4 v177, s[28:31], s5 offen offset:0 lds
  v_fmac_f32 v211, v18, v210
  s_waitcnt lgkmcnt(8)
  v_mfma_f32_32x32x16_bf16 v[96:111], a[216:219], a[100:103], v[96:111]
  ds_read_b64_tr_b16 a[240:241], v182 offset:19456
  ds_read_b64_tr_b16 a[242:243], v182 offset:19712
  v_fmac_f32 v195, v20, v210
  v_fmac_f32 v211, v19, v194
  v_cvt_pk_bf16_f32 v240, v192, v193
  v_cvt_pk_bf16_f32 v241, v194, v195
  v_cvt_pk_bf16_f32 v242, -v208, -v209
  v_cvt_pk_bf16_f32 v243, -v210, -v211
  v_mfma_f32_32x32x16_bf16 v[112:127], a[220:223], a[100:103], v[112:127]
  ds_read_b64_tr_b16 a[244:245], v182 offset:23552
  ds_read_b64_tr_b16 a[246:247], v182 offset:23808
  ds_write_b64 v29, v[240:241]
  ds_write_b64 v29, v[242:243] offset:2048
  v_fmac_f32 v196, v18, v195
  v_fmac_f32 v212, v18, v211
  s_waitcnt lgkmcnt(10)
  v_mfma_f32_32x32x16_bf16 v[64:79], a[224:227], a[104:107], v[64:79]
  ds_read_b64_tr_b16 a[248:249], v182 offset:27648
  s_add_u32 m0, s61, 106496
  ds_read_b64_tr_b16 a[250:251], v182 offset:27904
  buffer_load_dwordx4 v179, s[28:31], s5 offen offset:0 lds
  v_fmac_f32 v196, v20, v211
  v_mfma_f32_32x32x16_bf16 v[80:95], a[228:231], a[104:107], v[80:95]
  ds_read_b64_tr_b16 a[252:253], v182 offset:31744
  ds_read_b64_tr_b16 a[254:255], v182 offset:32000
  v_fmac_f32 v212, v19, v195
  v_fmac_f32 v197, v18, v196
  v_fmac_f32 v213, v18, v212
  v_fmac_f32 v197, v20, v212
  v_fmac_f32 v213, v19, v196
  v_fmac_f32 v198, v18, v197
  s_waitcnt lgkmcnt(10)
  v_mfma_f32_32x32x16_bf16 v[96:111], a[232:235], a[104:107], v[96:111]
  s_barrier
  ds_read_b64_tr_b16 a[192:193], v182 offset:32768
  ds_read_b64_tr_b16 a[194:195], v182 offset:33024
  v_fmac_f32 v214, v18, v213
  v_fmac_f32 v198, v20, v213
  v_fmac_f32 v214, v19, v197
  v_fmac_f32 v199, v18, v198
  v_mfma_f32_32x32x16_bf16 v[112:127], a[236:239], a[104:107], v[112:127]
  ds_read_b64_tr_b16 a[196:197], v182 offset:36864
  s_add_u32 m0, s61, 102400
  ds_read_b64_tr_b16 a[198:199], v182 offset:37120
  buffer_load_dwordx4 v176, s[32:35], s5 offen offset:0 lds
  buffer_store_dword v14, v9, s[44:47], 0 offen sc1
  s_waitcnt lgkmcnt(10)
  v_mfma_f32_32x32x16_bf16 v[64:79], a[240:243], a[108:111], v[64:79]
  ds_read_b64_tr_b16 a[200:201], v182 offset:40960
  ds_read_b64_tr_b16 a[202:203], v182 offset:41216
  v_fmac_f32 v215, v18, v214
  v_fmac_f32 v199, v20, v214
  v_fmac_f32 v215, v19, v198
  v_cvt_pk_bf16_f32 v244, v196, v197
  v_cvt_pk_bf16_f32 v245, v198, v199
  v_cvt_pk_bf16_f32 v246, -v212, -v213
  v_mfma_f32_32x32x16_bf16 v[80:95], a[244:247], a[108:111], v[80:95]
  ds_read_b64_tr_b16 a[204:205], v182 offset:45056
  ds_read_b64_tr_b16 a[206:207], v182 offset:45312
  v_cvt_pk_bf16_f32 v247, -v214, -v215
  ds_write_b64 v30, v[244:245]
  ds_write_b64 v30, v[246:247] offset:2048
  v_fmac_f32 v200, v18, v199
  v_fmac_f32 v216, v18, v215
  s_waitcnt lgkmcnt(10)
  v_mfma_f32_32x32x16_bf16 v[96:111], a[248:251], a[108:111], v[96:111]
  ds_read_b64_tr_b16 a[208:209], v182 offset:33792
  s_add_u32 m0, s61, 118784
  ds_read_b64_tr_b16 a[210:211], v182 offset:34048
  buffer_load_dwordx4 v178, s[32:35], s5 offen offset:0 lds
  v_mfma_f32_32x32x16_bf16 v[112:127], a[252:255], a[108:111], v[112:127]
  ds_read_b64_tr_b16 a[212:213], v182 offset:37888
  ds_read_b64_tr_b16 a[214:215], v182 offset:38144
  v_fmac_f32 v200, v20, v215
  v_fmac_f32 v216, v19, v199
  v_fmac_f32 v201, v18, v200
  v_fmac_f32 v217, v18, v216
  v_fmac_f32 v201, v20, v216
  v_fmac_f32 v217, v19, v200
  v_fmac_f32 v202, v18, v201
  s_waitcnt lgkmcnt(10)
  v_mfma_f32_32x32x16_bf16 v[64:79], a[192:195], a[112:115], v[64:79]
  ds_read_b64_tr_b16 a[216:217], v182 offset:41984
  ds_read_b64_tr_b16 a[218:219], v182 offset:42240
  v_fmac_f32 v218, v18, v217
  v_fmac_f32 v202, v20, v217
  v_fmac_f32 v218, v19, v201
  v_fmac_f32 v203, v18, v202
  v_fmac_f32 v219, v18, v218
  v_fmac_f32 v203, v20, v218
  v_mfma_f32_32x32x16_bf16 v[80:95], a[196:199], a[112:115], v[80:95]
  ds_read_b64_tr_b16 a[220:221], v182 offset:46080
  s_add_u32 m0, s61, 110592
  ds_read_b64_tr_b16 a[222:223], v182 offset:46336
  buffer_load_dwordx4 v179, s[32:35], s5 offen offset:0 lds
  v_fmac_f32 v219, v19, v202
  s_waitcnt lgkmcnt(10)
  v_mfma_f32_32x32x16_bf16 v[96:111], a[200:203], a[112:115], v[96:111]
  ds_read_b64_tr_b16 a[224:225], v182 offset:34816
  ds_read_b64_tr_b16 a[226:227], v182 offset:35072
  v_cvt_pk_bf16_f32 v240, v200, v201
  v_cvt_pk_bf16_f32 v241, v202, v203
  v_cvt_pk_bf16_f32 v242, -v216, -v217
  v_cvt_pk_bf16_f32 v243, -v218, -v219
  ds_write_b64 v31, v[240:241]
  v_mfma_f32_32x32x16_bf16 v[112:127], a[204:207], a[112:115], v[112:127]
  ds_read_b64_tr_b16 a[228:229], v182 offset:38912
  ds_read_b64_tr_b16 a[230:231], v182 offset:39168
  ds_write_b64 v31, v[242:243] offset:2048
  v_fmac_f32 v204, v18, v203
  v_fmac_f32 v220, v18, v219
  v_fmac_f32 v204, v20, v219
  v_fmac_f32 v220, v19, v203
  v_fmac_f32 v205, v18, v204
  s_waitcnt lgkmcnt(10)
  v_mfma_f32_32x32x16_bf16 v[64:79], a[208:211], a[116:119], v[64:79]
  ds_read_b64_tr_b16 a[232:233], v182 offset:43008
  ds_read_b64_tr_b16 a[234:235], v182 offset:43264
  v_fmac_f32 v221, v18, v220
  v_fmac_f32 v205, v20, v220
  v_fmac_f32 v221, v19, v204
  v_fmac_f32 v206, v18, v205
  v_fmac_f32 v222, v18, v221
  v_fmac_f32 v206, v20, v221
  v_mfma_f32_32x32x16_bf16 v[80:95], a[212:215], a[116:119], v[80:95]
  ds_read_b64_tr_b16 a[236:237], v182 offset:47104
  ds_read_b64_tr_b16 a[238:239], v182 offset:47360
  v_fmac_f32 v222, v19, v205
  v_fmac_f32 v207, v18, v206
  v_fmac_f32 v223, v18, v222
  v_fmac_f32 v207, v20, v222
  v_fmac_f32 v223, v19, v206
  v_cvt_pk_bf16_f32 v244, v204, v205
  v_cvt_pk_bf16_f32 v245, v206, v207
  s_waitcnt lgkmcnt(10)
  v_mfma_f32_32x32x16_bf16 v[96:111], a[216:219], a[116:119], v[96:111]
  ds_read_b64_tr_b16 a[240:241], v182 offset:35840
  ds_read_b64_tr_b16 a[242:243], v182 offset:36096
  v_cvt_pk_bf16_f32 v246, -v220, -v221
  v_cvt_pk_bf16_f32 v247, -v222, -v223
  ds_write_b64 v32, v[244:245]
  ds_write_b64 v32, v[246:247] offset:2048
  v_mfma_f32_32x32x16_bf16 v[112:127], a[220:223], a[116:119], v[112:127]
  ds_read_b64_tr_b16 a[244:245], v182 offset:39936
  ds_read_b64_tr_b16 a[246:247], v182 offset:40192
  ds_read_b64_tr_b16 v[192:193], v33 offset:0
  ds_read_b64_tr_b16 v[194:195], v34 offset:0
  ds_read_b64_tr_b16 v[196:197], v33 offset:1024
  ds_read_b64_tr_b16 v[198:199], v34 offset:1024
  ds_read_b64_tr_b16 v[200:201], v33 offset:2048
  ds_read_b64_tr_b16 v[202:203], v34 offset:2048
  s_waitcnt lgkmcnt(15)
  v_mfma_f32_32x32x16_bf16 v[64:79], a[224:227], a[120:123], v[64:79]
  ds_read_b64_tr_b16 a[248:249], v182 offset:44032
  ds_read_b64_tr_b16 a[250:251], v182 offset:44288
  ds_read_b64_tr_b16 v[204:205], v33 offset:3072
  ds_read_b64_tr_b16 v[206:207], v34 offset:3072
  s_waitcnt lgkmcnt(8)
  buffer_store_dwordx4 v[192:195], v5, s[44:47], s7 offen offset:3072 sc1
  v_mfma_f32_32x32x16_bf16 v[80:95], a[228:231], a[120:123], v[80:95]
  ds_read_b64_tr_b16 a[252:253], v182 offset:48128
  ds_read_b64_tr_b16 a[254:255], v182 offset:48384
  s_waitcnt lgkmcnt(8)
  buffer_store_dwordx4 v[196:199], v5, s[44:47], s98 offen offset:0 sc1
  v_mfma_f32_32x32x16_bf16 v[96:111], a[232:235], a[120:123], v[96:111]
  s_waitcnt vmcnt(15)
  s_barrier
  ds_read_b64_tr_b16 a[192:193], v182 offset:49152
  ds_read_b64_tr_b16 a[194:195], v182 offset:49408
  s_add_u32 m0, s61, 122880
  s_lshr_b32 s5, s0, 1
  s_xor_b32 s5, s5, 3
  s_mul_i32 s5, s5, 458752
  buffer_load_dwordx4 v176, s[28:31], s5 offen offset:0 lds
  v_mfma_f32_32x32x16_bf16 v[112:127], a[236:239], a[120:123], v[112:127]
  ds_read_b64_tr_b16 a[196:197], v182 offset:53248
  ds_read_b64_tr_b16 a[198:199], v182 offset:53504
  s_waitcnt lgkmcnt(10)
  buffer_store_dwordx4 v[200:203], v5, s[44:47], s98 offen offset:1024 sc1
  v_mfma_f32_32x32x16_bf16 v[64:79], a[240:243], a[124:127], v[64:79]
  ds_read_b64_tr_b16 a[200:201], v183 offset:0
  ds_read_b64_tr_b16 a[202:203], v184 offset:0
  s_waitcnt lgkmcnt(8)
  buffer_store_dwordx4 v[204:207], v5, s[44:47], s98 offen offset:2048 sc1
  v_mfma_f32_32x32x16_bf16 v[80:95], a[244:247], a[124:127], v[80:95]
  ds_read_b64_tr_b16 a[204:205], v182 offset:57344
  s_add_u32 m0, s61, 139264
  ds_read_b64_tr_b16 a[206:207], v182 offset:57600
  buffer_load_dwordx4 v177, s[28:31], s5 offen offset:0 lds
  v_mfma_f32_32x32x16_bf16 v[96:111], a[248:251], a[124:127], v[96:111]
  ds_read_b64_tr_b16 a[208:209], v182 offset:61440
  ds_read_b64_tr_b16 a[210:211], v182 offset:61696
  s_waitcnt lgkmcnt(8)
  v_mfma_f32_32x32x16_bf16 v[112:127], a[252:255], a[124:127], v[112:127]
  ds_read_b64_tr_b16 a[212:213], v183 offset:512
  ds_read_b64_tr_b16 a[214:215], v184 offset:512
  v_mfma_f32_32x32x16_bf16 v[128:143], a[192:195], a[0:3], 0
  ds_read_b64_tr_b16 a[216:217], v182 offset:50176
  s_add_u32 m0, s61, 131072
  ds_read_b64_tr_b16 a[218:219], v182 offset:50432
  buffer_load_dwordx4 v179, s[28:31], s5 offen offset:0 lds
  s_waitcnt lgkmcnt(8)
  v_mfma_f32_32x32x16_bf16 v[144:159], a[196:199], a[0:3], 0
  ds_read_b64_tr_b16 a[220:221], v182 offset:54272
  ds_read_b64_tr_b16 a[222:223], v182 offset:54528
  v_mul_f32 v224, s3, v64
  v_mul_f32 v225, s3, v65
  v_mul_f32 v226, s3, v66
  v_mul_f32 v227, s3, v67
  v_mul_f32 v228, s3, v68
  v_mul_f32 v229, s3, v69
  v_mfma_f32_32x32x16_bf16 v[160:175], a[200:203], a[0:3], 0
  ds_read_b64_tr_b16 a[224:225], v183 offset:1024
  ds_read_b64_tr_b16 a[226:227], v184 offset:1024
  v_mul_f32 v230, s3, v70
  v_mul_f32 v231, s3, v71
  v_exp_f32 v224, v224
  v_mul_f32 v64, v64, v96
  s_waitcnt lgkmcnt(8)
  v_mfma_f32_32x32x16_bf16 v[128:143], a[204:207], a[4:7], v[128:143]
  ds_read_b64_tr_b16 a[228:229], v182 offset:58368
  s_add_u32 m0, s61, 126976
  ds_read_b64_tr_b16 a[230:231], v182 offset:58624
  buffer_load_dwordx4 v176, s[32:35], s5 offen offset:0 lds
  v_mfma_f32_32x32x16_bf16 v[144:159], a[208:211], a[4:7], v[144:159]
  ds_read_b64_tr_b16 a[232:233], v182 offset:62464
  ds_read_b64_tr_b16 a[234:235], v182 offset:62720
  v_exp_f32 v225, v225
  v_mul_f32 v65, v65, v97
  v_exp_f32 v226, v226
  v_mul_f32 v66, v66, v98
  s_waitcnt lgkmcnt(8)
  v_mfma_f32_32x32x16_bf16 v[160:175], a[212:215], a[4:7], v[160:175]
  ds_read_b64_tr_b16 a[236:237], v183 offset:1536
  ds_read_b64_tr_b16 a[238:239], v184 offset:1536
  v_exp_f32 v227, v227
  v_mul_f32 v67, v67, v99
  v_exp_f32 v228, v228
  v_mul_f32 v68, v68, v100
  v_mfma_f32_32x32x16_bf16 v[128:143], a[216:219], a[8:11], v[128:143]
  ds_read_b64_tr_b16 a[240:241], v182 offset:51200
  s_add_u32 m0, s61, 143360
  ds_read_b64_tr_b16 a[242:243], v182 offset:51456
  buffer_load_dwordx4 v178, s[32:35], s5 offen offset:0 lds
  s_waitcnt lgkmcnt(8)
  v_mfma_f32_32x32x16_bf16 v[144:159], a[220:223], a[8:11], v[144:159]
  ds_read_b64_tr_b16 a[244:245], v182 offset:55296
  ds_read_b64_tr_b16 a[246:247], v182 offset:55552
  v_exp_f32 v229, v229
  v_mul_f32 v69, v69, v101
  v_exp_f32 v230, v230
  v_mul_f32 v70, v70, v102
  v_mfma_f32_32x32x16_bf16 v[160:175], a[224:227], a[8:11], v[160:175]
  ds_read_b64_tr_b16 a[248:249], v183 offset:2048
  ds_read_b64_tr_b16 a[250:251], v184 offset:2048
  v_exp_f32 v231, v231
  v_mul_f32 v71, v71, v103
  v_add_f32 v224, 1.0, v224
  v_add_f32 v225, 1.0, v225
  v_add_f32 v226, 1.0, v226
  v_add_f32 v227, 1.0, v227
  s_waitcnt lgkmcnt(8)
  v_mfma_f32_32x32x16_bf16 v[128:143], a[228:231], a[12:15], v[128:143]
  ds_read_b64_tr_b16 a[252:253], v182 offset:59392
  s_add_u32 m0, s61, 135168
  ds_read_b64_tr_b16 a[254:255], v182 offset:59648
  buffer_load_dwordx4 v179, s[32:35], s5 offen offset:0 lds
  s_waitcnt vmcnt(5)
  v_mov_b32 v17, 1
  buffer_store_dword v17, v7, s[44:47], 0 offen sc1
  v_mfma_f32_32x32x16_bf16 v[144:159], a[232:235], a[12:15], v[144:159]
  ds_read_b64_tr_b16 a[192:193], v182 offset:63488
  ds_read_b64_tr_b16 a[194:195], v182 offset:63744
  v_add_f32 v228, 1.0, v228
  v_add_f32 v229, 1.0, v229
  v_add_f32 v230, 1.0, v230
  v_add_f32 v231, 1.0, v231
  v_rcp_f32 v224, v224
  s_waitcnt lgkmcnt(8)
  v_mfma_f32_32x32x16_bf16 v[160:175], a[236:239], a[12:15], v[160:175]
  ds_read_b64_tr_b16 a[196:197], v183 offset:2560
  ds_read_b64_tr_b16 a[198:199], v184 offset:2560
  v_rcp_f32 v225, v225
  v_mul_f32 v64, v64, v224
  v_rcp_f32 v226, v226
  v_mul_f32 v65, v65, v225
  v_mfma_f32_32x32x16_bf16 v[128:143], a[240:243], a[16:19], v[128:143]
  ds_read_b64_tr_b16 a[200:201], v182 offset:52224
  ds_read_b64_tr_b16 a[202:203], v182 offset:52480
  v_rcp_f32 v227, v227
  v_mul_f32 v66, v66, v226
  v_rcp_f32 v228, v228
  v_mul_f32 v67, v67, v227
  s_waitcnt lgkmcnt(8)
  v_mfma_f32_32x32x16_bf16 v[144:159], a[244:247], a[16:19], v[144:159]
  ds_read_b64_tr_b16 a[204:205], v182 offset:56320
  ds_read_b64_tr_b16 a[206:207], v182 offset:56576
  v_rcp_f32 v229, v229
  v_mul_f32 v68, v68, v228
  v_rcp_f32 v230, v230
  v_mfma_f32_32x32x16_bf16 v[160:175], a[248:251], a[16:19], v[160:175]
  ds_read_b64_tr_b16 a[208:209], v183 offset:3072
  ds_read_b64_tr_b16 a[210:211], v184 offset:3072
  v_mul_f32 v69, v69, v229
  v_rcp_f32 v231, v231
  v_mul_f32 v70, v70, v230
  v_cvt_pk_bf16_f32 v232, v64, v65
  v_mul_f32 v71, v71, v231
  s_waitcnt lgkmcnt(8)
  v_mfma_f32_32x32x16_bf16 v[128:143], a[252:255], a[20:23], v[128:143]
  ds_read_b64_tr_b16 a[212:213], v182 offset:60416
  ds_read_b64_tr_b16 a[214:215], v182 offset:60672
  v_cvt_pk_bf16_f32 v233, v66, v67
  v_cvt_pk_bf16_f32 v234, v68, v69
  v_cvt_pk_bf16_f32 v235, v70, v71
  buffer_store_dwordx4 v[232:235], v5, s[44:47], 0 offen offset:0 sc1
  v_mfma_f32_32x32x16_bf16 v[144:159], a[192:195], a[20:23], v[144:159]
  ds_read_b64_tr_b16 a[216:217], v182 offset:64512
  ds_read_b64_tr_b16 a[218:219], v182 offset:64768
  v_mul_f32 v224, s3, v72
  v_mul_f32 v225, s3, v73
  v_mul_f32 v226, s3, v74
  s_waitcnt lgkmcnt(8)
  v_mfma_f32_32x32x16_bf16 v[160:175], a[196:199], a[20:23], v[160:175]
  ds_read_b64_tr_b16 a[220:221], v183 offset:3584
  ds_read_b64_tr_b16 a[222:223], v184 offset:3584
  v_mul_f32 v227, s3, v75
  v_mul_f32 v228, s3, v76
  v_mul_f32 v229, s3, v77
  v_mul_f32 v230, s3, v78
  v_mul_f32 v231, s3, v79
  v_mfma_f32_32x32x16_bf16 v[128:143], a[200:203], a[24:27], v[128:143]
  s_barrier
  ds_read_b64_tr_b16 a[224:225], v180 offset:8192
  s_add_u32 m0, s61, 16384
  ds_read_b64_tr_b16 a[226:227], v180 offset:8448
  buffer_load_dwordx4 v2, s[20:23], 0 offen offset:0 lds
  s_waitcnt lgkmcnt(8)
  v_mfma_f32_32x32x16_bf16 v[144:159], a[204:207], a[24:27], v[144:159]
  ds_read_b64_tr_b16 a[228:229], v180 offset:12288
  ds_read_b64_tr_b16 a[230:231], v180 offset:12544
  v_exp_f32 v224, v224
  v_mul_f32 v72, v72, v104
  v_exp_f32 v225, v225
  v_mul_f32 v73, v73, v105
  v_mfma_f32_32x32x16_bf16 v[160:175], a[208:211], a[24:27], v[160:175]
  ds_read_b64_tr_b16 a[232:233], v183 offset:24576
  ds_read_b64_tr_b16 a[234:235], v184 offset:24576
  v_exp_f32 v226, v226
  v_mul_f32 v74, v74, v106
  v_exp_f32 v227, v227
  v_mul_f32 v75, v75, v107
  s_waitcnt lgkmcnt(8)
  v_mfma_f32_32x32x16_bf16 v[128:143], a[212:215], a[28:31], v[128:143]
  ds_read_b64_tr_b16 a[236:237], v180 offset:16384
  s_add_u32 m0, s61, 24576
  ds_read_b64_tr_b16 a[238:239], v180 offset:16640
  buffer_load_dwordx4 v43, s[20:23], 0 offen offset:0 lds
  v_mfma_f32_32x32x16_bf16 v[144:159], a[216:219], a[28:31], v[144:159]
  ds_read_b64_tr_b16 a[240:241], v180 offset:20480
  ds_read_b64_tr_b16 a[242:243], v180 offset:20736
  v_exp_f32 v228, v228
  v_mul_f32 v76, v76, v108
  v_exp_f32 v229, v229
  v_mul_f32 v77, v77, v109
  s_waitcnt lgkmcnt(8)
  v_mfma_f32_32x32x16_bf16 v[160:175], a[220:223], a[28:31], v[160:175]
  ds_read_b64_tr_b16 a[244:245], v183 offset:25088
  ds_read_b64_tr_b16 a[246:247], v184 offset:25088
  v_exp_f32 v230, v230
  v_mul_f32 v78, v78, v110
  v_exp_f32 v231, v231
  v_mul_f32 v79, v79, v111
  v_add_f32 v224, 1.0, v224
  v_mfma_f32_32x32x16_bf16 v[128:143], a[224:227], a[32:35], v[128:143]
  ds_read_b64_tr_b16 a[248:249], v180 offset:9216
  ds_read_b64_tr_b16 a[250:251], v180 offset:9472
  s_add_u32 m0, s61, 20480
  s_mov_b32 s5, 16384
  buffer_load_dwordx4 v2, s[20:23], s5 offen offset:0 lds
  s_waitcnt lgkmcnt(8)
  v_mfma_f32_32x32x16_bf16 v[144:159], a[228:231], a[32:35], v[144:159]
  ds_read_b64_tr_b16 a[252:253], v180 offset:13312
  ds_read_b64_tr_b16 a[254:255], v180 offset:13568
  v_add_f32 v225, 1.0, v225
  v_add_f32 v226, 1.0, v226
  v_add_f32 v227, 1.0, v227
  v_add_f32 v228, 1.0, v228
  v_add_f32 v229, 1.0, v229
  v_add_f32 v230, 1.0, v230
  v_mfma_f32_32x32x16_bf16 v[160:175], a[232:235], a[32:35], v[160:175]
  ds_read_b64_tr_b16 a[192:193], v183 offset:25600
  ds_read_b64_tr_b16 a[194:195], v184 offset:25600
  v_add_f32 v231, 1.0, v231
  v_rcp_f32 v224, v224
  v_rcp_f32 v225, v225
  v_mul_f32 v72, v72, v224
  s_waitcnt lgkmcnt(8)
  v_mfma_f32_32x32x16_bf16 v[128:143], a[236:239], a[36:39], v[128:143]
  ds_read_b64_tr_b16 a[196:197], v180 offset:17408
  s_add_u32 m0, s61, 28672
  ds_read_b64_tr_b16 a[198:199], v180 offset:17664
  buffer_load_dwordx4 v43, s[20:23], s5 offen offset:0 lds
  v_mfma_f32_32x32x16_bf16 v[144:159], a[240:243], a[36:39], v[144:159]
  ds_read_b64_tr_b16 a[200:201], v180 offset:21504
  ds_read_b64_tr_b16 a[202:203], v180 offset:21760
  v_rcp_f32 v226, v226
  v_mul_f32 v73, v73, v225
  v_rcp_f32 v227, v227
  v_mul_f32 v74, v74, v226
  s_waitcnt lgkmcnt(8)
  v_mfma_f32_32x32x16_bf16 v[160:175], a[244:247], a[36:39], v[160:175]
  ds_read_b64_tr_b16 a[204:205], v183 offset:26112
  ds_read_b64_tr_b16 a[206:207], v184 offset:26112
  v_rcp_f32 v228, v228
  v_mul_f32 v75, v75, v227
  v_rcp_f32 v229, v229
  v_mfma_f32_32x32x16_bf16 v[128:143], a[248:251], a[40:43], v[128:143]
  ds_read_b64_tr_b16 a[208:209], v180 offset:10240
  ds_read_b64_tr_b16 a[210:211], v180 offset:10496
  v_mul_f32 v76, v76, v228
  v_rcp_f32 v230, v230
  v_mul_f32 v77, v77, v229
  v_rcp_f32 v231, v231
  s_waitcnt lgkmcnt(8)
  v_mfma_f32_32x32x16_bf16 v[144:159], a[252:255], a[40:43], v[144:159]
  ds_read_b64_tr_b16 a[212:213], v180 offset:14336
  ds_read_b64_tr_b16 a[214:215], v180 offset:14592
  v_mul_f32 v78, v78, v230
  v_cvt_pk_bf16_f32 v236, v72, v73
  v_mul_f32 v79, v79, v231
  v_cvt_pk_bf16_f32 v237, v74, v75
  v_cvt_pk_bf16_f32 v238, v76, v77
  v_cvt_pk_bf16_f32 v239, v78, v79
  v_mfma_f32_32x32x16_bf16 v[160:175], a[192:195], a[40:43], v[160:175]
  ds_read_b64_tr_b16 a[216:217], v183 offset:26624
  ds_read_b64_tr_b16 a[218:219], v184 offset:26624
  buffer_store_dwordx4 v[236:239], v5, s[44:47], 0 offen offset:1024 sc1
  s_waitcnt lgkmcnt(8)
  v_mfma_f32_32x32x16_bf16 v[128:143], a[196:199], a[44:47], v[128:143]
  ds_read_b64_tr_b16 a[220:221], v180 offset:18432
  ds_read_b64_tr_b16 a[222:223], v180 offset:18688
  v_mul_f32 v224, s3, v80
  v_mul_f32 v225, s3, v81
  v_mul_f32 v226, s3, v82
  v_mul_f32 v227, s3, v83
  v_mul_f32 v228, s3, v84
  v_mul_f32 v229, s3, v85
  v_mfma_f32_32x32x16_bf16 v[144:159], a[200:203], a[44:47], v[144:159]
  ds_read_b64_tr_b16 a[224:225], v180 offset:22528
  ds_read_b64_tr_b16 a[226:227], v180 offset:22784
  v_mul_f32 v230, s3, v86
  v_mul_f32 v231, s3, v87
  v_exp_f32 v224, v224
  v_mul_f32 v80, v80, v112
  s_waitcnt lgkmcnt(8)
  v_mfma_f32_32x32x16_bf16 v[160:175], a[204:207], a[44:47], v[160:175]
  ds_read_b64_tr_b16 a[228:229], v183 offset:27136
  ds_read_b64_tr_b16 a[230:231], v184 offset:27136
  v_exp_f32 v225, v225
  v_mul_f32 v81, v81, v113
  v_exp_f32 v226, v226
  v_mul_f32 v82, v82, v114
  v_mfma_f32_32x32x16_bf16 v[128:143], a[208:211], a[48:51], v[128:143]
  ds_read_b64_tr_b16 a[232:233], v180 offset:11264
  ds_read_b64_tr_b16 a[234:235], v180 offset:11520
  v_exp_f32 v227, v227
  v_mul_f32 v83, v83, v115
  v_exp_f32 v228, v228
  v_mul_f32 v84, v84, v116
  s_waitcnt lgkmcnt(8)
  v_mfma_f32_32x32x16_bf16 v[144:159], a[212:215], a[48:51], v[144:159]
  ds_read_b64_tr_b16 a[236:237], v180 offset:15360
  ds_read_b64_tr_b16 a[238:239], v180 offset:15616
  v_exp_f32 v229, v229
  v_mul_f32 v85, v85, v117
  v_exp_f32 v230, v230
  v_mul_f32 v86, v86, v118
  buffer_load_dword v13, v6, s[44:47], 0 offen sc1
  v_mfma_f32_32x32x16_bf16 v[160:175], a[216:219], a[48:51], v[160:175]
  ds_read_b64_tr_b16 a[240:241], v183 offset:27648
  ds_read_b64_tr_b16 a[242:243], v184 offset:27648
  v_exp_f32 v231, v231
  v_mul_f32 v87, v87, v119
  v_add_f32 v224, 1.0, v224
  v_add_f32 v225, 1.0, v225
  v_add_f32 v226, 1.0, v226
  v_add_f32 v227, 1.0, v227
  s_waitcnt lgkmcnt(8)
  v_mfma_f32_32x32x16_bf16 v[128:143], a[220:223], a[52:55], v[128:143]
  ds_read_b64_tr_b16 a[244:245], v180 offset:19456
  ds_read_b64_tr_b16 a[246:247], v180 offset:19712
  v_add_f32 v228, 1.0, v228
  v_add_f32 v229, 1.0, v229
  v_add_f32 v230, 1.0, v230
  v_add_f32 v231, 1.0, v231
  v_rcp_f32 v224, v224
  v_mfma_f32_32x32x16_bf16 v[144:159], a[224:227], a[52:55], v[144:159]
  ds_read_b64_tr_b16 a[248:249], v180 offset:23552
  ds_read_b64_tr_b16 a[250:251], v180 offset:23808
  v_rcp_f32 v225, v225
  v_mul_f32 v80, v80, v224
  v_rcp_f32 v226, v226
  s_waitcnt lgkmcnt(8)
  v_mfma_f32_32x32x16_bf16 v[160:175], a[228:231], a[52:55], v[160:175]
  ds_read_b64_tr_b16 a[252:253], v183 offset:28160
  ds_read_b64_tr_b16 a[254:255], v184 offset:28160
  v_mul_f32 v81, v81, v225
  v_rcp_f32 v227, v227
  v_mul_f32 v82, v82, v226
  v_rcp_f32 v228, v228
  v_mfma_f32_32x32x16_bf16 v[128:143], a[232:235], a[56:59], v[128:143]
  s_barrier
  ds_read_b64_tr_b16 a[192:193], v180 offset:32768
  s_add_u32 m0, s61, 49152
  ds_read_b64_tr_b16 a[194:195], v180 offset:33024
  buffer_load_dwordx4 v2, s[24:27], 0 offen offset:0 lds
  s_waitcnt lgkmcnt(8)
  v_mfma_f32_32x32x16_bf16 v[144:159], a[236:239], a[56:59], v[144:159]
  ds_read_b64_tr_b16 a[196:197], v180 offset:36864
  ds_read_b64_tr_b16 a[198:199], v180 offset:37120
  v_mul_f32 v83, v83, v227
  v_rcp_f32 v229, v229
  v_mul_f32 v84, v84, v228
  v_rcp_f32 v230, v230
  v_mfma_f32_32x32x16_bf16 v[160:175], a[240:243], a[56:59], v[160:175]
  ds_read_b64_tr_b16 a[200:201], v183 offset:49152
  ds_read_b64_tr_b16 a[202:203], v184 offset:49152
  v_mul_f32 v85, v85, v229
  v_rcp_f32 v231, v231
  v_mul_f32 v86, v86, v230
  v_cvt_pk_bf16_f32 v232, v80, v81
  v_mul_f32 v87, v87, v231
  s_waitcnt lgkmcnt(8)
  v_mfma_f32_32x32x16_bf16 v[128:143], a[244:247], a[60:63], v[128:143]
  ds_read_b64_tr_b16 a[204:205], v180 offset:40960
  s_add_u32 m0, s61, 57344
  ds_read_b64_tr_b16 a[206:207], v180 offset:41216
  buffer_load_dwordx4 v43, s[24:27], 0 offen offset:0 lds
  v_mfma_f32_32x32x16_bf16 v[144:159], a[248:251], a[60:63], v[144:159]
  ds_read_b64_tr_b16 a[208:209], v180 offset:45056
  ds_read_b64_tr_b16 a[210:211], v180 offset:45312
  v_cvt_pk_bf16_f32 v233, v82, v83
  v_cvt_pk_bf16_f32 v234, v84, v85
  v_cvt_pk_bf16_f32 v235, v86, v87
  buffer_store_dwordx4 v[232:235], v5, s[44:47], 0 offen offset:2048 sc1
  s_waitcnt lgkmcnt(8)
  v_mfma_f32_32x32x16_bf16 v[160:175], a[252:255], a[60:63], v[160:175]
  ds_read_b64_tr_b16 a[212:213], v183 offset:49664
  ds_read_b64_tr_b16 a[214:215], v184 offset:49664
  v_mul_f32 v224, s3, v88
  v_mul_f32 v225, s3, v89
  v_mul_f32 v226, s3, v90
  v_mfma_f32_32x32x16_bf16 v[128:143], a[192:195], a[64:67], v[128:143]
  ds_read_b64_tr_b16 a[216:217], v180 offset:33792
  s_add_u32 m0, s61, 53248
  ds_read_b64_tr_b16 a[218:219], v180 offset:34048
  buffer_load_dwordx4 v2, s[24:27], s5 offen offset:0 lds
  s_waitcnt lgkmcnt(8)
  v_mfma_f32_32x32x16_bf16 v[144:159], a[196:199], a[64:67], v[144:159]
  ds_read_b64_tr_b16 a[220:221], v180 offset:37888
  ds_read_b64_tr_b16 a[222:223], v180 offset:38144
  v_mul_f32 v227, s3, v91
  v_mul_f32 v228, s3, v92
  v_mul_f32 v229, s3, v93
  v_mul_f32 v230, s3, v94
  v_mul_f32 v231, s3, v95
  v_mfma_f32_32x32x16_bf16 v[160:175], a[200:203], a[64:67], v[160:175]
  ds_read_b64_tr_b16 a[224:225], v183 offset:50176
  ds_read_b64_tr_b16 a[226:227], v184 offset:50176
  v_exp_f32 v224, v224
  v_mul_f32 v88, v88, v120
  v_exp_f32 v225, v225
  v_mul_f32 v89, v89, v121
  s_waitcnt lgkmcnt(8)
  v_mfma_f32_32x32x16_bf16 v[128:143], a[204:207], a[68:71], v[128:143]
  ds_read_b64_tr_b16 a[228:229], v180 offset:41984
  s_add_u32 m0, s61, 61440
  ds_read_b64_tr_b16 a[230:231], v180 offset:42240
  buffer_load_dwordx4 v43, s[24:27], s5 offen offset:0 lds
  v_exp_f32 v226, v226
  v_mfma_f32_32x32x16_bf16 v[144:159], a[208:211], a[68:71], v[144:159]
  ds_read_b64_tr_b16 a[232:233], v180 offset:46080
  ds_read_b64_tr_b16 a[234:235], v180 offset:46336
  v_mul_f32 v90, v90, v122
  v_exp_f32 v227, v227
  v_mul_f32 v91, v91, v123
  s_waitcnt lgkmcnt(8)
  v_mfma_f32_32x32x16_bf16 v[160:175], a[212:215], a[68:71], v[160:175]
  ds_read_b64_tr_b16 a[236:237], v183 offset:50688
  ds_read_b64_tr_b16 a[238:239], v184 offset:50688
  v_exp_f32 v228, v228
  v_mul_f32 v92, v92, v124
  v_exp_f32 v229, v229
  v_mul_f32 v93, v93, v125
  v_mfma_f32_32x32x16_bf16 v[128:143], a[216:219], a[72:75], v[128:143]
  ds_read_b64_tr_b16 a[240:241], v180 offset:34816
  ds_read_b64_tr_b16 a[242:243], v180 offset:35072
  v_exp_f32 v230, v230
  v_mul_f32 v94, v94, v126
  v_exp_f32 v231, v231
  v_mul_f32 v95, v95, v127
  v_add_f32 v224, 1.0, v224
  s_waitcnt lgkmcnt(8)
  v_mfma_f32_32x32x16_bf16 v[144:159], a[220:223], a[72:75], v[144:159]
  ds_read_b64_tr_b16 a[244:245], v180 offset:38912
  ds_read_b64_tr_b16 a[246:247], v180 offset:39168
  v_add_f32 v225, 1.0, v225
  v_add_f32 v226, 1.0, v226
  v_add_f32 v227, 1.0, v227
  v_add_f32 v228, 1.0, v228
  v_add_f32 v229, 1.0, v229
  v_add_f32 v230, 1.0, v230
  v_mfma_f32_32x32x16_bf16 v[160:175], a[224:227], a[72:75], v[160:175]
  ds_read_b64_tr_b16 a[248:249], v183 offset:51200
  ds_read_b64_tr_b16 a[250:251], v184 offset:51200
  v_add_f32 v231, 1.0, v231
  v_rcp_f32 v224, v224
  v_rcp_f32 v225, v225
  v_mul_f32 v88, v88, v224
  s_waitcnt lgkmcnt(8)
  v_mfma_f32_32x32x16_bf16 v[128:143], a[228:231], a[76:79], v[128:143]
  ds_read_b64_tr_b16 a[252:253], v180 offset:43008
  ds_read_b64_tr_b16 a[254:255], v180 offset:43264
  v_rcp_f32 v226, v226
  v_mul_f32 v89, v89, v225
  v_rcp_f32 v227, v227
  s_waitcnt vmcnt(5)
  v_cmp_gt_u32 vcc, 1, v13
  s_nop 0
  s_cbranch_vccz SPD2
  s_mov_b32 s6, 0
SP2:
  buffer_load_dword v13, v6, s[44:47], 0 offen sc1
  s_add_u32 s6, s6, 1
  s_waitcnt vmcnt(0)
  s_cmp_gt_u32 s6, 300000
  s_cbranch_scc1 SPD2
  v_cmp_gt_u32 vcc, 1, v13
  s_nop 0
  s_cbranch_vccnz SP2
SPD2:
  v_mfma_f32_32x32x16_bf16 v[144:159], a[232:235], a[76:79], v[144:159]
  ds_read_b64_tr_b16 a[192:193], v180 offset:47104
  ds_read_b64_tr_b16 a[194:195], v180 offset:47360
  s_add_u32 m0, s61, 147456
  s_xor_b32 s5, s99, 7168
  buffer_load_dwordx4 v3, s[44:47], s5 offen offset:0 sc1 lds
  s_waitcnt lgkmcnt(8)
  v_mfma_f32_32x32x16_bf16 v[160:175], a[236:239], a[76:79], v[160:175]
  ds_read_b64_tr_b16 a[196:197], v183 offset:51712
  ds_read_b64_tr_b16 a[198:199], v184 offset:51712
  v_mul_f32 v90, v90, v226
  v_rcp_f32 v228, v228
  v_mul_f32 v91, v91, v227
  v_rcp_f32 v229, v229
  v_mfma_f32_32x32x16_bf16 v[128:143], a[240:243], a[80:83], v[128:143]
  ds_read_b64_tr_b16 a[200:201], v180 offset:35840
  ds_read_b64_tr_b16 a[202:203], v180 offset:36096
  v_mul_f32 v92, v92, v228
  v_rcp_f32 v230, v230
  v_mul_f32 v93, v93, v229
  v_rcp_f32 v231, v231
  s_waitcnt lgkmcnt(8)
  v_mfma_f32_32x32x16_bf16 v[144:159], a[244:247], a[80:83], v[144:159]
  ds_read_b64_tr_b16 a[204:205], v180 offset:39936
  ds_read_b64_tr_b16 a[206:207], v180 offset:40192
  s_add_u32 m0, s61, 151552
  s_xor_b32 s5, s99, 8192
  buffer_load_dwordx4 v3, s[44:47], s5 offen offset:0 sc1 lds
  v_mfma_f32_32x32x16_bf16 v[160:175], a[248:251], a[80:83], v[160:175]
  ds_read_b64_tr_b16 a[208:209], v183 offset:52224
  ds_read_b64_tr_b16 a[210:211], v184 offset:52224
  v_mul_f32 v94, v94, v230
  v_cvt_pk_bf16_f32 v236, v88, v89
  v_mul_f32 v95, v95, v231
  v_cvt_pk_bf16_f32 v237, v90, v91
  v_cvt_pk_bf16_f32 v238, v92, v93
  v_cvt_pk_bf16_f32 v239, v94, v95
  s_waitcnt lgkmcnt(8)
  v_mfma_f32_32x32x16_bf16 v[128:143], a[252:255], a[84:87], v[128:143]
  ds_read_b64_tr_b16 a[212:213], v180 offset:44032
  ds_read_b64_tr_b16 a[214:215], v180 offset:44288
  buffer_store_dwordx4 v[236:239], v5, s[44:47], 0 offen offset:3072 sc1
  v_mfma_f32_32x32x16_bf16 v[144:159], a[192:195], a[84:87], v[144:159]
  ds_read_b64_tr_b16 a[216:217], v180 offset:48128
  ds_read_b64_tr_b16 a[218:219], v180 offset:48384
  s_add_u32 m0, s61, 155648
  s_xor_b32 s5, s99, 23552
  buffer_load_dwordx4 v3, s[44:47], s5 offen offset:0 sc1 lds
  s_waitcnt lgkmcnt(8)
  v_mfma_f32_32x32x16_bf16 v[160:175], a[196:199], a[84:87], v[160:175]
  ds_read_b64_tr_b16 a[220:221], v183 offset:52736
  ds_read_b64_tr_b16 a[222:223], v184 offset:52736
  v_mfma_f32_32x32x16_bf16 v[128:143], a[200:203], a[88:91], v[128:143]
  s_barrier
  ds_read_b64_tr_b16 a[224:225], v180 offset:57344
  ds_read_b64_tr_b16 a[226:227], v180 offset:57600
  s_waitcnt lgkmcnt(8)
  v_mfma_f32_32x32x16_bf16 v[144:159], a[204:207], a[88:91], v[144:159]
  ds_read_b64_tr_b16 a[228:229], v180 offset:61440
  ds_read_b64_tr_b16 a[230:231], v180 offset:61696
  s_add_u32 m0, s61, 159744
  s_xor_b32 s5, s99, 24576
  buffer_load_dwordx4 v3, s[44:47], s5 offen offset:0 sc1 lds
  v_mfma_f32_32x32x16_bf16 v[160:175], a[208:211], a[88:91], v[160:175]
  ds_read_b64_tr_b16 a[232:233], v185 offset:8192
  ds_read_b64_tr_b16 a[234:235], v186 offset:8192
  s_waitcnt lgkmcnt(8)
  v_mfma_f32_32x32x16_bf16 v[128:143], a[212:215], a[92:95], v[128:143]
  ds_read_b64_tr_b16 a[236:237], v181 offset:0
  ds_read_b64_tr_b16 a[238:239], v181 offset:256
  v_mfma_f32_32x32x16_bf16 v[144:159], a[216:219], a[92:95], v[144:159]
  ds_read_b64_tr_b16 a[240:241], v181 offset:4096
  ds_read_b64_tr_b16 a[242:243], v181 offset:4352
  s_add_u32 m0, s61, 32768
  s_xor_b32 s5, s99, 9216
  buffer_load_dwordx4 v3, s[44:47], s5 offen offset:0 sc1 lds
  s_waitcnt lgkmcnt(8)
  v_mfma_f32_32x32x16_bf16 v[160:175], a[220:223], a[92:95], v[160:175]
  ds_read_b64_tr_b16 a[244:245], v185 offset:8704
  ds_read_b64_tr_b16 a[246:247], v186 offset:8704
  v_mfma_f32_32x32x16_bf16 v[128:143], a[224:227], a[96:99], v[128:143]
  ds_read_b64_tr_b16 a[248:249], v180 offset:58368
  ds_read_b64_tr_b16 a[250:251], v180 offset:58624
  s_waitcnt lgkmcnt(8)
  v_mfma_f32_32x32x16_bf16 v[144:159], a[228:231], a[96:99], v[144:159]
  ds_read_b64_tr_b16 a[252:253], v180 offset:62464
  ds_read_b64_tr_b16 a[254:255], v180 offset:62720
  s_add_u32 m0, s61, 36864
  s_xor_b32 s5, s99, 10240
  buffer_load_dwordx4 v3, s[44:47], s5 offen offset:0 sc1 lds
  v_mfma_f32_32x32x16_bf16 v[160:175], a[232:235], a[96:99], v[160:175]
  ds_read_b64_tr_b16 a[192:193], v185 offset:9216
  ds_read_b64_tr_b16 a[194:195], v186 offset:9216
  s_waitcnt lgkmcnt(8)
  v_mfma_f32_32x32x16_bf16 v[128:143], a[236:239], a[100:103], v[128:143]
  ds_read_b64_tr_b16 a[196:197], v181 offset:1024
  ds_read_b64_tr_b16 a[198:199], v181 offset:1280
  v_mfma_f32_32x32x16_bf16 v[144:159], a[240:243], a[100:103], v[144:159]
  ds_read_b64_tr_b16 a[200:201], v181 offset:5120
  ds_read_b64_tr_b16 a[202:203], v181 offset:5376
  s_add_u32 m0, s61, 40960
  s_xor_b32 s5, s99, 25600
  buffer_load_dwordx4 v3, s[44:47], s5 offen offset:0 sc1 lds
  s_waitcnt lgkmcnt(8)
  v_mfma_f32_32x32x16_bf16 v[160:175], a[244:247], a[100:103], v[160:175]
  ds_read_b64_tr_b16 a[204:205], v185 offset:9728
  ds_read_b64_tr_b16 a[206:207], v186 offset:9728
  v_mfma_f32_32x32x16_bf16 v[128:143], a[248:251], a[104:107], v[128:143]
  ds_read_b64_tr_b16 a[208:209], v180 offset:59392
  ds_read_b64_tr_b16 a[210:211], v180 offset:59648
  s_waitcnt lgkmcnt(8)
  v_mfma_f32_32x32x16_bf16 v[144:159], a[252:255], a[104:107], v[144:159]
  ds_read_b64_tr_b16 a[212:213], v180 offset:63488
  ds_read_b64_tr_b16 a[214:215], v180 offset:63744
  s_add_u32 m0, s61, 45056
  s_xor_b32 s5, s99, 26624
  buffer_load_dwordx4 v3, s[44:47], s5 offen offset:0 sc1 lds
  s_waitcnt vmcnt(6)
  v_mov_b32 v17, 2
  buffer_store_dword v17, v7, s[44:47], 0 offen sc1
  v_mfma_f32_32x32x16_bf16 v[160:175], a[192:195], a[104:107], v[160:175]
  ds_read_b64_tr_b16 a[216:217], v185 offset:10240
  ds_read_b64_tr_b16 a[218:219], v186 offset:10240
  s_waitcnt lgkmcnt(8)
  v_mfma_f32_32x32x16_bf16 v[128:143], a[196:199], a[108:111], v[128:143]
  ds_read_b64_tr_b16 a[220:221], v181 offset:2048
  ds_read_b64_tr_b16 a[222:223], v181 offset:2304
  v_mfma_f32_32x32x16_bf16 v[144:159], a[200:203], a[108:111], v[144:159]
  ds_read_b64_tr_b16 a[224:225], v181 offset:6144
  s_add_u32 m0, s61, 81920
  ds_read_b64_tr_b16 a[226:227], v181 offset:6400
  buffer_load_dwordx4 v44, s[20:23], 0 offen offset:0 lds
  s_waitcnt lgkmcnt(8)
  v_mfma_f32_32x32x16_bf16 v[160:175], a[204:207], a[108:111], v[160:175]
  ds_read_b64_tr_b16 a[228:229], v185 offset:10752
  ds_read_b64_tr_b16 a[230:231], v186 offset:10752
  v_mfma_f32_32x32x16_bf16 v[128:143], a[208:211], a[112:115], v[128:143]
  ds_read_b64_tr_b16 a[232:233], v180 offset:60416
  ds_read_b64_tr_b16 a[234:235], v180 offset:60672
  s_waitcnt lgkmcnt(8)
  v_mfma_f32_32x32x16_bf16 v[144:159], a[212:215], a[112:115], v[144:159]
  ds_read_b64_tr_b16 a[236:237], v180 offset:64512
  s_add_u32 m0, s61, 90112
  ds_read_b64_tr_b16 a[238:239], v180 offset:64768
  buffer_load_dwordx4 v45, s[20:23], 0 offen offset:0 lds
  v_mfma_f32_32x32x16_bf16 v[160:175], a[216:219], a[112:115], v[160:175]
  ds_read_b64_tr_b16 a[240:241], v185 offset:11264
  ds_read_b64_tr_b16 a[242:243], v186 offset:11264
  s_waitcnt lgkmcnt(8)
  v_mfma_f32_32x32x16_bf16 v[128:143], a[220:223], a[116:119], v[128:143]
  ds_read_b64_tr_b16 a[244:245], v181 offset:3072
  ds_read_b64_tr_b16 a[246:247], v181 offset:3328
  v_mfma_f32_32x32x16_bf16 v[144:159], a[224:227], a[116:119], v[144:159]
  ds_read_b64_tr_b16 a[248:249], v181 offset:7168
  ds_read_b64_tr_b16 a[250:251], v181 offset:7424
  s_add_u32 m0, s61, 86016
  s_mov_b32 s5, 16384
  buffer_load_dwordx4 v44, s[20:23], s5 offen offset:0 lds
  s_waitcnt lgkmcnt(8)
  v_mfma_f32_32x32x16_bf16 v[160:175], a[228:231], a[116:119], v[160:175]
  ds_read_b64_tr_b16 a[252:253], v185 offset:11776
  ds_read_b64_tr_b16 a[254:255], v186 offset:11776
  v_mfma_f32_32x32x16_bf16 v[128:143], a[232:235], a[120:123], v[128:143]
  s_waitcnt vmcnt(8)
  s_barrier
  ds_read_b128 a[128:131], v46 offset:16384
  ds_read_b128 a[132:135], v47 offset:16384
  s_waitcnt lgkmcnt(8)
  v_mfma_f32_32x32x16_bf16 v[144:159], a[236:239], a[120:123], v[144:159]
  s_add_u32 m0, s61, 94208
  ds_read_b128 a[136:139], v47 offset:17408
  buffer_load_dwordx4 v45, s[20:23], s5 offen offset:0 lds
  v_mfma_f32_32x32x16_bf16 v[160:175], a[240:243], a[120:123], v[160:175]
  ds_read_b128 a[140:143], v46 offset:17408
  s_waitcnt lgkmcnt(6)
  v_mfma_f32_32x32x16_bf16 v[128:143], a[244:247], a[124:127], v[128:143]
  v_mfma_f32_32x32x16_bf16 v[144:159], a[248:251], a[124:127], v[144:159]
  ds_read_b128 a[144:147], v48 offset:16384
  ds_read_b128 a[148:151], v47 offset:20480
  s_add_u32 m0, s61, 65536
  s_xor_b32 s5, s99, 39936
  buffer_load_dwordx4 v3, s[44:47], s5 offen offset:0 sc1 lds
  s_waitcnt lgkmcnt(4)
  v_mfma_f32_32x32x16_bf16 v[160:175], a[252:255], a[124:127], v[160:175]
  ds_read_b128 a[152:155], v47 offset:21504
  v_mfma_f32_32x32x16_bf16 v[64:79], a[128:131], a[132:135], 0
  ds_read_b128 a[156:159], v48 offset:17408
  s_nop 0
  v_mul_f32 v224, s3, v128
  v_mul_f32 v225, s3, v129
  v_mul_f32 v226, s3, v130
  v_mul_f32 v227, s3, v131
  v_mul_f32 v228, s3, v132
  v_mul_f32 v229, s3, v133
  v_mul_f32 v230, s3, v134
  v_mul_f32 v231, s3, v135
  v_exp_f32 v224, v224
  v_mul_f32 v128, v128, v144
  s_waitcnt lgkmcnt(4)
  v_mfma_f32_32x32x16_bf16 v[80:95], a[128:131], a[136:139], 0
  s_add_u32 m0, s61, 69632
  s_xor_b32 s5, s99, 40960
  buffer_load_dwordx4 v3, s[44:47], s5 offen offset:0 sc1 lds
  v_exp_f32 v225, v225
  v_mul_f32 v129, v129, v145
  v_exp_f32 v226, v226
  v_mfma_f32_32x32x16_bf16 v[96:111], a[140:143], a[132:135], 0
  ds_read_b128 a[160:163], v46 offset:24576
  ds_read_b128 a[164:167], v47 offset:24576
  s_add_u32 m0, s61, 73728
  s_xor_b32 s5, s99, 56320
  buffer_load_dwordx4 v3, s[44:47], s5 offen offset:0 sc1 lds
  v_mul_f32 v130, v130, v146
  v_exp_f32 v227, v227
  v_mfma_f32_32x32x16_bf16 v[112:127], a[140:143], a[136:139], 0
  ds_read_b128 a[168:171], v47 offset:25600
  v_mul_f32 v131, v131, v147
  v_exp_f32 v228, v228
  v_mul_f32 v132, v132, v148
  v_exp_f32 v229, v229
  v_mul_f32 v133, v133, v149
  v_exp_f32 v230, v230
  v_mul_f32 v134, v134, v150
  v_exp_f32 v231, v231
  s_waitcnt lgkmcnt(4)
  v_mfma_f32_32x32x16_bf16 v[64:79], a[144:147], a[148:151], v[64:79]
  ds_read_b128 a[172:175], v46 offset:25600
  s_add_u32 m0, s61, 77824
  s_xor_b32 s5, s99, 57344
  buffer_load_dwordx4 v3, s[44:47], s5 offen offset:0 sc1 lds
  v_mul_f32 v135, v135, v151
  v_add_f32 v224, 1.0, v224
  v_add_f32 v225, 1.0, v225
  v_mfma_f32_32x32x16_bf16 v[80:95], a[144:147], a[152:155], v[80:95]
  v_add_f32 v226, 1.0, v226
  v_add_f32 v227, 1.0, v227
  v_add_f32 v228, 1.0, v228
  v_add_f32 v229, 1.0, v229
  v_add_f32 v230, 1.0, v230
  v_add_f32 v231, 1.0, v231
  v_rcp_f32 v224, v224
  v_rcp_f32 v225, v225
  v_mul_f32 v128, v128, v224
  v_rcp_f32 v226, v226
  s_waitcnt lgkmcnt(4)
  v_mfma_f32_32x32x16_bf16 v[96:111], a[156:159], a[148:151], v[96:111]
  ds_read_b128 a[176:179], v48 offset:24576
  ds_read_b128 a[180:183], v47 offset:28672
  s_add_u32 m0, s61, 98304
  s_xor_b32 s5, s99, 41984
  buffer_load_dwordx4 v3, s[44:47], s5 offen offset:0 sc1 lds
  v_mul_f32 v129, v129, v225
  v_rcp_f32 v227, v227
  v_mfma_f32_32x32x16_bf16 v[112:127], a[156:159], a[152:155], v[112:127]
  ds_read_b128 a[184:187], v47 offset:29696
  v_mul_f32 v130, v130, v226
  v_rcp_f32 v228, v228
  v_mul_f32 v131, v131, v227
  v_rcp_f32 v229, v229
  v_mul_f32 v132, v132, v228
  v_rcp_f32 v230, v230
  v_mul_f32 v133, v133, v229
  s_waitcnt lgkmcnt(4)
  v_mfma_f32_32x32x16_bf16 v[64:79], a[160:163], a[164:167], v[64:79]
  ds_read_b128 a[188:191], v48 offset:25600
  s_add_u32 m0, s61, 102400
  s_xor_b32 s5, s99, 43008
  buffer_load_dwordx4 v3, s[44:47], s5 offen offset:0 sc1 lds
  v_rcp_f32 v231, v231
  v_mul_f32 v134, v134, v230
  v_cvt_pk_bf16_f32 v232, v128, v129
  v_mfma_f32_32x32x16_bf16 v[80:95], a[160:163], a[168:171], v[80:95]
  s_add_u32 m0, s61, 106496
  s_xor_b32 s5, s99, 58368
  buffer_load_dwordx4 v3, s[44:47], s5 offen offset:0 sc1 lds
  v_mul_f32 v135, v135, v231
  v_cvt_pk_bf16_f32 v233, v130, v131
  v_cvt_pk_bf16_f32 v234, v132, v133
  v_cvt_pk_bf16_f32 v235, v134, v135
  s_waitcnt lgkmcnt(4)
  v_mfma_f32_32x32x16_bf16 v[96:111], a[172:175], a[164:167], v[96:111]
  s_waitcnt vmcnt(12)
  s_barrier
  ds_read_b128 a[128:131], v46 offset:49152
  ds_read_b128 a[132:135], v49 offset:32768
  buffer_store_dwordx4 v[232:235], v5, s[44:47], s7 offen offset:0 sc1
  v_mfma_f32_32x32x16_bf16 v[112:127], a[172:175], a[168:171], v[112:127]
  s_add_u32 m0, s61, 114688
  ds_read_b128 a[136:139], v49 offset:33792
  buffer_load_dwordx4 v44, s[24:27], 0 offen offset:0 lds
  v_mul_f32 v224, s3, v136
  v_mul_f32 v225, s3, v137
  v_mul_f32 v226, s3, v138
  v_mul_f32 v227, s3, v139
  v_mul_f32 v228, s3, v140
  s_waitcnt lgkmcnt(4)
  v_mfma_f32_32x32x16_bf16 v[64:79], a[176:179], a[180:183], v[64:79]
  ds_read_b128 a[140:143], v46 offset:50176
  v_mul_f32 v229, s3, v141
  v_mul_f32 v230, s3, v142
  v_mul_f32 v231, s3, v143
  v_exp_f32 v224, v224
  v_mul_f32 v136, v136, v152
  v_exp_f32 v225, v225
  v_mul_f32 v137, v137, v153
  v_exp_f32 v226, v226
  s_add_u32 m0, s61, 122880
  v_mfma_f32_32x32x16_bf16 v[80:95], a[176:179], a[184:187], v[80:95]
  buffer_load_dwordx4 v45, s[24:27], 0 offen offset:0 lds
  v_mul_f32 v138, v138, v154
  v_exp_f32 v227, v227
  v_mul_f32 v139, v139, v155
  v_exp_f32 v228, v228
  s_waitcnt lgkmcnt(4)
  v_mfma_f32_32x32x16_bf16 v[96:111], a[188:191], a[180:183], v[96:111]
  ds_read_b128 a[144:147], v48 offset:49152
  ds_read_b128 a[148:151], v49 offset:36864
  v_mul_f32 v140, v140, v156
  v_exp_f32 v229, v229
  v_mul_f32 v141, v141, v157
  v_exp_f32 v230, v230
  v_mul_f32 v142, v142, v158
  v_exp_f32 v231, v231
  v_mul_f32 v143, v143, v159
  v_mfma_f32_32x32x16_bf16 v[112:127], a[188:191], a[184:187], v[112:127]
  ds_read_b128 a[152:155], v49 offset:37888
  s_add_u32 m0, s61, 118784
  s_mov_b32 s5, 16384
  buffer_load_dwordx4 v44, s[24:27], s5 offen offset:0 lds
  v_add_f32 v224, 1.0, v224
  v_add_f32 v225, 1.0, v225
  v_add_f32 v226, 1.0, v226
  v_add_f32 v227, 1.0, v227
  s_waitcnt lgkmcnt(4)
  v_mfma_f32_32x32x16_bf16 v[64:79], a[128:131], a[132:135], v[64:79]
  s_add_u32 m0, s61, 126976
  ds_read_b128 a[156:159], v48 offset:50176
  buffer_load_dwordx4 v45, s[24:27], s5 offen offset:0 lds
  v_add_f32 v228, 1.0, v228
  v_add_f32 v229, 1.0, v229
  v_add_f32 v230, 1.0, v230
  v_add_f32 v231, 1.0, v231
  v_rcp_f32 v224, v224
  v_mfma_f32_32x32x16_bf16 v[80:95], a[128:131], a[136:139], v[80:95]
  v_rcp_f32 v225, v225
  v_mul_f32 v136, v136, v224
  v_rcp_f32 v226, v226
  v_mul_f32 v137, v137, v225
  v_rcp_f32 v227, v227
  v_mul_f32 v138, v138, v226
  v_rcp_f32 v228, v228
  s_waitcnt lgkmcnt(4)
  v_mfma_f32_32x32x16_bf16 v[96:111], a[140:143], a[132:135], v[96:111]
  ds_read_b128 a[160:163], v46 offset:57344
  ds_read_b128 a[164:167], v49 offset:40960
  s_add_u32 m0, s61, 110592
  s_xor_b32 s5, s99, 59392
  buffer_load_dwordx4 v3, s[44:47], s5 offen offset:0 sc1 lds
  v_mul_f32 v139, v139, v227
  v_rcp_f32 v229, v229
  v_mfma_f32_32x32x16_bf16 v[112:127], a[140:143], a[136:139], v[112:127]
  ds_read_b128 a[168:171], v49 offset:41984
  v_mul_f32 v140, v140, v228
  v_rcp_f32 v230, v230
  v_mul_f32 v141, v141, v229
  v_rcp_f32 v231, v231
  v_mul_f32 v142, v142, v230
  v_cvt_pk_bf16_f32 v236, v136, v137
  v_mul_f32 v143, v143, v231
  v_cvt_pk_bf16_f32 v237, v138, v139
  v_cvt_pk_bf16_f32 v238, v140, v141
  buffer_load_dword v13, v6, s[44:47], 0 offen sc1
  s_waitcnt lgkmcnt(4)
  v_mfma_f32_32x32x16_bf16 v[64:79], a[144:147], a[148:151], v[64:79]
  ds_read_b128 a[172:175], v46 offset:58368
  v_cvt_pk_bf16_f32 v239, v142, v143
  buffer_store_dwordx4 v[236:239], v5, s[44:47], s7 offen offset:1024 sc1
  v_mul_f32 v224, s3, v160
  v_mul_f32 v225, s3, v161
  v_mul_f32 v226, s3, v162
  v_mul_f32 v227, s3, v163
  v_mfma_f32_32x32x16_bf16 v[80:95], a[144:147], a[152:155], v[80:95]
  v_mul_f32 v228, s3, v164
  v_mul_f32 v229, s3, v165
  v_mul_f32 v230, s3, v166
  v_mul_f32 v231, s3, v167
  v_exp_f32 v224, v224
  v_mul_f32 v160, v160, v168
  v_exp_f32 v225, v225
  v_mul_f32 v161, v161, v169
  v_exp_f32 v226, v226
  s_waitcnt lgkmcnt(4)
  v_mfma_f32_32x32x16_bf16 v[96:111], a[156:159], a[148:151], v[96:111]
  ds_read_b128 a[176:179], v48 offset:57344
  ds_read_b128 a[180:183], v49 offset:45056
  v_mul_f32 v162, v162, v170
  v_exp_f32 v227, v227
  v_mul_f32 v163, v163, v171
  v_exp_f32 v228, v228
  v_mul_f32 v164, v164, v172
  v_exp_f32 v229, v229
  v_mfma_f32_32x32x16_bf16 v[112:127], a[156:159], a[152:155], v[112:127]
  ds_read_b128 a[184:187], v49 offset:46080
  v_mul_f32 v165, v165, v173
  v_exp_f32 v230, v230
  v_mul_f32 v166, v166, v174
  v_exp_f32 v231, v231
  v_mul_f32 v167, v167, v175
  v_add_f32 v224, 1.0, v224
  v_add_f32 v225, 1.0, v225
  v_add_f32 v226, 1.0, v226
  v_add_f32 v227, 1.0, v227
  s_waitcnt lgkmcnt(4)
  v_mfma_f32_32x32x16_bf16 v[64:79], a[160:163], a[164:167], v[64:79]
  ds_read_b128 a[188:191], v48 offset:58368
  v_add_f32 v228, 1.0, v228
  v_add_f32 v229, 1.0, v229
  v_add_f32 v230, 1.0, v230
  v_add_f32 v231, 1.0, v231
  v_rcp_f32 v224, v224
  v_rcp_f32 v225, v225
  v_mul_f32 v160, v160, v224
  v_rcp_f32 v226, v226
  v_mfma_f32_32x32x16_bf16 v[80:95], a[160:163], a[168:171], v[80:95]
  v_mul_f32 v161, v161, v225
  v_rcp_f32 v227, v227
  v_mul_f32 v162, v162, v226
  v_rcp_f32 v228, v228
  v_mul_f32 v163, v163, v227
  v_rcp_f32 v229, v229
  v_mul_f32 v164, v164, v228
  v_rcp_f32 v230, v230
  s_waitcnt lgkmcnt(4)
  v_mfma_f32_32x32x16_bf16 v[96:111], a[172:175], a[164:167], v[96:111]
  s_waitcnt vmcnt(11)
  s_barrier
  ds_read_b128 a[128:131], v50 offset:16384
  ds_read_b128 a[132:135], v51 offset:0
  s_add_u32 m0, s61, 147456
  s_xor_b32 s5, s100, 0
  buffer_load_dwordx4 v1, s[36:39], s5 offen offset:0 lds
  v_mfma_f32_32x32x16_bf16 v[112:127], a[172:175], a[168:171], v[112:127]
  s_add_u32 m0, s61, 151488
  ds_read_b128 a[136:139], v51 offset:1024
  buffer_load_dwordx4 v1, s[36:39], s5 offen offset:64 lds
  v_mul_f32 v165, v165, v229
  v_rcp_f32 v231, v231
  v_mul_f32 v166, v166, v230
  s_waitcnt lgkmcnt(4)
  v_mfma_f32_32x32x16_bf16 v[64:79], a[176:179], a[180:183], v[64:79]
  ds_read_b128 a[140:143], v50 offset:17408
  v_cvt_pk_bf16_f32 v232, v160, v161
  v_mul_f32 v167, v167, v231
  v_cvt_pk_bf16_f32 v233, v162, v163
  v_cvt_pk_bf16_f32 v234, v164, v165
  v_cvt_pk_bf16_f32 v235, v166, v167
  buffer_store_dwordx4 v[232:235], v5, s[44:47], s7 offen offset:2048 sc1
  v_mfma_f32_32x32x16_bf16 v[80:95], a[176:179], a[184:187], v[80:95]
  s_add_u32 m0, s61, 155648
  s_xor_b32 s5, s100, 32768
  buffer_load_dwordx4 v1, s[36:39], s5 offen offset:0 lds
  s_waitcnt lgkmcnt(4)
  v_mfma_f32_32x32x16_bf16 v[96:111], a[188:191], a[180:183], v[96:111]
  ds_read_b128 a[144:147], v52 offset:16384
  ds_read_b128 a[148:151], v51 offset:4096
  v_mfma_f32_32x32x16_bf16 v[112:127], a[188:191], a[184:187], v[112:127]
  s_add_u32 m0, s61, 159680
  ds_read_b128 a[152:155], v51 offset:5120
  buffer_load_dwordx4 v1, s[36:39], s5 offen offset:64 lds
  s_waitcnt lgkmcnt(4)
  v_mfma_f32_32x32x16_bf16 v[64:79], a[128:131], a[132:135], v[64:79]
  ds_read_b128 a[156:159], v52 offset:17408
  v_mfma_f32_32x32x16_bf16 v[80:95], a[128:131], a[136:139], v[80:95]
  s_waitcnt lgkmcnt(4)
  v_mfma_f32_32x32x16_bf16 v[96:111], a[140:143], a[132:135], v[96:111]
  ds_read_b128 a[160:163], v50 offset:24576
  ds_read_b128 a[164:167], v51 offset:8192
  v_mfma_f32_32x32x16_bf16 v[112:127], a[140:143], a[136:139], v[112:127]
  ds_read_b128 a[168:171], v51 offset:9216
  s_waitcnt lgkmcnt(4)
  v_mfma_f32_32x32x16_bf16 v[64:79], a[144:147], a[148:151], v[64:79]
  ds_read_b128 a[172:175], v50 offset:25600
  v_mfma_f32_32x32x16_bf16 v[80:95], a[144:147], a[152:155], v[80:95]
  s_waitcnt lgkmcnt(4)
  v_mfma_f32_32x32x16_bf16 v[96:111], a[156:159], a[148:151], v[96:111]
  ds_read_b128 a[176:179], v52 offset:24576
  ds_read_b128 a[180:183], v51 offset:12288
  v_mfma_f32_32x32x16_bf16 v[112:127], a[156:159], a[152:155], v[112:127]
  ds_read_b128 a[184:187], v51 offset:13312
  s_waitcnt vmcnt(6)
  v_cmp_gt_u32 vcc, 2, v13
  s_nop 0
  s_cbranch_vccz SPD3
  s_mov_b32 s6, 0
SP3:
  buffer_load_dword v13, v6, s[44:47], 0 offen sc1
  s_add_u32 s6, s6, 1
  s_waitcnt vmcnt(0)
  s_cmp_gt_u32 s6, 300000
  s_cbranch_scc1 SPD3
  v_cmp_gt_u32 vcc, 2, v13
  s_nop 0
  s_cbranch_vccnz SP3
SPD3:
  s_waitcnt lgkmcnt(4)
  v_mfma_f32_32x32x16_bf16 v[64:79], a[160:163], a[164:167], v[64:79]
  ds_read_b128 a[188:191], v52 offset:25600
  s_add_u32 m0, s61, 131072
  s_xor_b32 s5, s99, 0
  buffer_load_dwordx4 v3, s[44:47], s5 offen offset:0 sc1 lds
  v_mfma_f32_32x32x16_bf16 v[80:95], a[160:163], a[168:171], v[80:95]
  s_add_u32 m0, s61, 135168
  s_xor_b32 s5, s99, 1024
  buffer_load_dwordx4 v3, s[44:47], s5 offen offset:0 sc1 lds
  s_waitcnt lgkmcnt(4)
  v_mfma_f32_32x32x16_bf16 v[96:111], a[172:175], a[164:167], v[96:111]
  s_barrier
  ds_read_b128 a[128:131], v50 offset:49152
  ds_read_b128 a[132:135], v51 offset:32768
  v_mfma_f32_32x32x16_bf16 v[112:127], a[172:175], a[168:171], v[112:127]
  ds_read_b128 a[136:139], v51 offset:33792
  s_add_u32 m0, s61, 139264
  s_xor_b32 s5, s99, 2048
  buffer_load_dwordx4 v3, s[44:47], s5 offen offset:0 sc1 lds
  s_waitcnt vmcnt(5)
  v_mov_b32 v17, 3
  buffer_store_dword v17, v7, s[44:47], 0 offen sc1
  buffer_load_dword v13, v38, s[44:47], 0 offen sc1
  s_waitcnt lgkmcnt(4)
  v_mfma_f32_32x32x16_bf16 v[64:79], a[176:179], a[180:183], v[64:79]
  ds_read_b128 a[140:143], v50 offset:50176
  v_mfma_f32_32x32x16_bf16 v[80:95], a[176:179], a[184:187], v[80:95]
  s_add_u32 m0, s61, 143360
  s_xor_b32 s5, s99, 3072
  buffer_load_dwordx4 v3, s[44:47], s5 offen offset:0 sc1 lds
  s_waitcnt lgkmcnt(4)
  v_mfma_f32_32x32x16_bf16 v[96:111], a[188:191], a[180:183], v[96:111]
  ds_read_b128 a[144:147], v52 offset:49152
  ds_read_b128 a[148:151], v51 offset:36864
  v_mfma_f32_32x32x16_bf16 v[112:127], a[188:191], a[184:187], v[112:127]
  ds_read_b128 a[152:155], v51 offset:37888
  s_add_u32 m0, s61, 32768
  s_xor_b32 s5, s100, 131072
  buffer_load_dwordx4 v1, s[36:39], s5 offen offset:0 lds
  s_waitcnt lgkmcnt(4)
  v_mfma_f32_32x32x16_bf16 v[64:79], a[128:131], a[132:135], v[64:79]
  s_add_u32 m0, s61, 36800
  ds_read_b128 a[156:159], v52 offset:50176
  buffer_load_dwordx4 v1, s[36:39], s5 offen offset:64 lds
  v_mfma_f32_32x32x16_bf16 v[80:95], a[128:131], a[136:139], v[80:95]
  s_waitcnt lgkmcnt(4)
  v_mfma_f32_32x32x16_bf16 v[96:111], a[140:143], a[132:135], v[96:111]
  ds_read_b128 a[160:163], v50 offset:57344
  ds_read_b128 a[164:167], v51 offset:40960
  s_add_u32 m0, s61, 40960
  s_xor_b32 s5, s100, 163840
  buffer_load_dwordx4 v1, s[36:39], s5 offen offset:0 lds
  v_mfma_f32_32x32x16_bf16 v[112:127], a[140:143], a[136:139], v[112:127]
  ds_read_b128 a[168:171], v51 offset:41984
  s_waitcnt lgkmcnt(4)
  v_mfma_f32_32x32x16_bf16 v[64:79], a[144:147], a[148:151], v[64:79]
  s_add_u32 m0, s61, 44992
  ds_read_b128 a[172:175], v50 offset:58368
  buffer_load_dwordx4 v1, s[36:39], s5 offen offset:64 lds
  v_mfma_f32_32x32x16_bf16 v[80:95], a[144:147], a[152:155], v[80:95]
  s_waitcnt lgkmcnt(4)
  v_mfma_f32_32x32x16_bf16 v[96:111], a[156:159], a[148:151], v[96:111]
  ds_read_b128 a[176:179], v52 offset:57344
  ds_read_b128 a[180:183], v51 offset:45056
  s_add_u32 m0, s61, 16384
  s_xor_b32 s5, s99, 16384
  buffer_load_dwordx4 v3, s[44:47], s5 offen offset:0 sc1 lds
  v_mfma_f32_32x32x16_bf16 v[112:127], a[156:159], a[152:155], v[112:127]
  ds_read_b128 a[184:187], v51 offset:46080
  s_add_u32 m0, s61, 20480
  s_xor_b32 s5, s99, 17408
  buffer_load_dwordx4 v3, s[44:47], s5 offen offset:0 sc1 lds
  s_waitcnt lgkmcnt(4)
  v_mfma_f32_32x32x16_bf16 v[64:79], a[160:163], a[164:167], v[64:79]
  ds_read_b128 a[188:191], v52 offset:58368
  v_mfma_f32_32x32x16_bf16 v[80:95], a[160:163], a[168:171], v[80:95]
  s_add_u32 m0, s61, 24576
  s_xor_b32 s5, s99, 18432
  buffer_load_dwordx4 v3, s[44:47], s5 offen offset:0 sc1 lds
  s_waitcnt lgkmcnt(4)
  v_mfma_f32_32x32x16_bf16 v[96:111], a[172:175], a[164:167], v[96:111]
  s_waitcnt vmcnt(7)
  s_barrier
  ds_read_b64_tr_b16 a[128:129], v53 offset:16384
  ds_read_b64_tr_b16 a[130:131], v53 offset:16896
  ds_read_b128 a[132:135], v47 offset:0
  v_mfma_f32_32x32x16_bf16 v[112:127], a[172:175], a[168:171], v[112:127]
  ds_read_b128 a[136:139], v47 offset:1024
  s_add_u32 m0, s61, 28672
  s_xor_b32 s5, s99, 19456
  buffer_load_dwordx4 v3, s[44:47], s5 offen offset:0 sc1 lds
  s_waitcnt lgkmcnt(5)
  v_mfma_f32_32x32x16_bf16 v[64:79], a[176:179], a[180:183], v[64:79]
  ds_read_b64_tr_b16 a[140:141], v53 offset:20480
  ds_read_b64_tr_b16 a[142:143], v53 offset:20992
  v_mfma_f32_32x32x16_bf16 v[80:95], a[176:179], a[184:187], v[80:95]
  s_add_u32 m0, s61, 65536
  s_xor_b32 s5, s100, 262144
  buffer_load_dwordx4 v1, s[36:39], s5 offen offset:0 lds
  s_waitcnt lgkmcnt(6)
  v_mfma_f32_32x32x16_bf16 v[96:111], a[188:191], a[180:183], v[96:111]
  ds_read_b64_tr_b16 a[144:145], v53 offset:18432
  ds_read_b64_tr_b16 a[146:147], v53 offset:18944
  s_add_u32 m0, s61, 69568
  ds_read_b128 a[148:151], v47 offset:4096
  buffer_load_dwordx4 v1, s[36:39], s5 offen offset:64 lds
  v_mfma_f32_32x32x16_bf16 v[112:127], a[188:191], a[184:187], v[112:127]
  ds_read_b128 a[152:155], v47 offset:5120
  v_cmp_gt_u32 vcc, 1, v13
  s_nop 0
  s_cbranch_vccz SPD5
  s_mov_b32 s6, 0
SP5:
  buffer_load_dword v13, v38, s[44:47], 0 offen sc1
  s_add_u32 s6, s6, 1
  s_waitcnt vmcnt(0)
  s_cmp_gt_u32 s6, 300000
  s_cbranch_scc1 SPD5
  v_cmp_gt_u32 vcc, 1, v13
  s_nop 0
  s_cbranch_vccnz SP5
SPD5:
  s_waitcnt lgkmcnt(6)
  v_mfma_f32_32x32x16_bf16 v[128:143], a[128:131], a[132:135], 0
  ds_read_b64_tr_b16 a[156:157], v53 offset:22528
  ds_read_b64_tr_b16 a[158:159], v53 offset:23040
  s_add_u32 m0, s61, 73728
  s_xor_b32 s5, s100, 294912
  buffer_load_dwordx4 v1, s[36:39], s5 offen offset:0 lds
  v_mfma_f32_32x32x16_bf16 v[144:159], a[128:131], a[136:139], 0
  s_lshl_b32 s62, s57, 1
  s_and_b32 s63, s59, 1
  s_add_u32 s62, s62, s63
  s_lshl_b32 s62, s62, 1
  s_and_b32 s63, s56, 1
  s_add_u32 s62, s62, s63
  s_lshl_b32 s62, s62, 5
  v_bfe_u32 v220, v35, 3, 2
  v_lshl_add_u32 v220, v37, 4, v220
  v_add_u32 v214, s62, v220
  s_waitcnt lgkmcnt(6)
  v_mfma_f32_32x32x16_bf16 v[160:175], a[140:143], a[132:135], 0
  ds_read_b64_tr_b16 a[160:161], v53 offset:24576
  ds_read_b64_tr_b16 a[162:163], v53 offset:25088
  s_add_u32 m0, s61, 77760
  ds_read_b128 a[164:167], v47 offset:8192
  buffer_load_dwordx4 v1, s[36:39], s5 offen offset:64 lds
  v_mfma_f32_32x32x16_bf16 v[176:191], a[140:143], a[136:139], 0
  ds_read_b128 a[168:171], v47 offset:9216
  s_lshl_b32 s62, s62, 2
  s_add_u32 s62, s62, 16842752
  v_lshrrev_b32 v220, 3, v35
  v_lshlrev_b32 v213, 2, v220
  buffer_load_dword v200, v213, s[44:47], s62 offen offset:0 sc1
  s_waitcnt lgkmcnt(6)
  v_mfma_f32_32x32x16_bf16 v[128:143], a[144:147], a[148:151], v[128:143]
  ds_read_b64_tr_b16 a[172:173], v53 offset:28672
  ds_read_b64_tr_b16 a[174:175], v53 offset:29184
  s_add_u32 m0, s61, 49152
  s_xor_b32 s5, s99, 32768
  buffer_load_dwordx4 v3, s[44:47], s5 offen offset:0 sc1 lds
  v_mfma_f32_32x32x16_bf16 v[144:159], a[144:147], a[152:155], v[144:159]
  s_add_u32 m0, s61, 53248
  s_xor_b32 s5, s99, 33792
  buffer_load_dwordx4 v3, s[44:47], s5 offen offset:0 sc1 lds
  s_waitcnt lgkmcnt(6)
  v_mfma_f32_32x32x16_bf16 v[160:175], a[156:159], a[148:151], v[160:175]
  ds_read_b64_tr_b16 a[176:177], v53 offset:26624
  ds_read_b64_tr_b16 a[178:179], v53 offset:27136
  ds_read_b128 a[180:183], v47 offset:12288
  buffer_load_dword v201, v213, s[44:47], s62 offen offset:32 sc1
  v_mfma_f32_32x32x16_bf16 v[176:191], a[156:159], a[152:155], v[176:191]
  ds_read_b128 a[184:187], v47 offset:13312
  s_add_u32 m0, s61, 57344
  s_xor_b32 s5, s99, 34816
  buffer_load_dwordx4 v3, s[44:47], s5 offen offset:0 sc1 lds
  s_waitcnt lgkmcnt(6)
  v_mfma_f32_32x32x16_bf16 v[128:143], a[160:163], a[164:167], v[128:143]
  ds_read_b64_tr_b16 a[188:189], v53 offset:30720
  ds_read_b64_tr_b16 a[190:191], v53 offset:31232
  buffer_load_dword v202, v213, s[44:47], s62 offen offset:64 sc1
  buffer_load_dword v203, v213, s[44:47], s62 offen offset:96 sc1
  v_mfma_f32_32x32x16_bf16 v[144:159], a[160:163], a[168:171], v[144:159]
  s_add_u32 m0, s61, 61440
  s_xor_b32 s5, s99, 35840
  buffer_load_dwordx4 v3, s[44:47], s5 offen offset:0 sc1 lds
  s_waitcnt lgkmcnt(6)
  v_mfma_f32_32x32x16_bf16 v[160:175], a[172:175], a[164:167], v[160:175]
  s_waitcnt vmcnt(12)
  s_barrier
  ds_read_b64_tr_b16 a[128:129], v54 offset:32768
  ds_read_b64_tr_b16 a[130:131], v54 offset:33280
  ds_read_b128 a[132:135], v49 offset:16384
  v_mfma_f32_32x32x16_bf16 v[176:191], a[172:175], a[168:171], v[176:191]
  ds_read_b128 a[136:139], v49 offset:17408
  s_add_u32 m0, s61, 98304
  s_xor_b32 s5, s100, 393216
  buffer_load_dwordx4 v1, s[36:39], s5 offen offset:0 lds
  s_lshl_b32 s62, s60, 1
  s_waitcnt lgkmcnt(6)
  v_mfma_f32_32x32x16_bf16 v[128:143], a[176:179], a[180:183], v[128:143]
  ds_read_b64_tr_b16 a[140:141], v54 offset:36864
  s_add_u32 m0, s61, 102336
  ds_read_b64_tr_b16 a[142:143], v54 offset:37376
  buffer_load_dwordx4 v1, s[36:39], s5 offen offset:64 lds
  v_mfma_f32_32x32x16_bf16 v[144:159], a[176:179], a[184:187], v[144:159]
  s_lshr_b32 s63, s59, 1
  s_add_u32 s62, s62, s63
  s_lshl_b32 s62, s62, 1
  s_lshr_b32 s63, s56, 1
  s_add_u32 s62, s62, s63
  s_lshl_b32 s62, s62, 6
  v_and_b32 v221, 7, v35
  v_lshl_add_u32 v215, v221, 3, s62
  s_waitcnt lgkmcnt(6)
  v_mfma_f32_32x32x16_bf16 v[160:175], a[188:191], a[180:183], v[160:175]
  ds_read_b64_tr_b16 a[144:145], v54 offset:34816
  ds_read_b64_tr_b16 a[146:147], v54 offset:35328
  ds_read_b128 a[148:151], v49 offset:20480
  s_add_u32 m0, s61, 106496
  s_xor_b32 s5, s100, 425984
  buffer_load_dwordx4 v1, s[36:39], s5 offen offset:0 lds
  v_mfma_f32_32x32x16_bf16 v[176:191], a[188:191], a[184:187], v[176:191]
  ds_read_b128 a[152:155], v49 offset:21504
  s_mov_b32 s16, s80
  s_mov_b32 s17, s81
  s_mov_b32 s18, 1024
  s_mov_b32 s19, 0x20000
  buffer_load_dwordx2 v[204:205], v215, s[16:19], 0 offen
  v_lshl_add_u32 v215, v214, 10, v215
  s_waitcnt lgkmcnt(6)
  v_mfma_f32_32x32x16_bf16 v[128:143], a[128:131], a[132:135], v[128:143]
  ds_read_b64_tr_b16 a[156:157], v54 offset:38912
  s_add_u32 m0, s61, 110528
  ds_read_b64_tr_b16 a[158:159], v54 offset:39424
  buffer_load_dwordx4 v1, s[36:39], s5 offen offset:64 lds
  v_lshlrev_b32 v214, 1, v215
  v_mfma_f32_32x32x16_bf16 v[144:159], a[128:131], a[136:139], v[144:159]
  buffer_load_dwordx2 v[192:193], v215, s[8:11], 0 offen
  s_mov_b32 s62, 4096
  buffer_load_dwordx2 v[194:195], v215, s[8:11], s62 offen
  s_waitcnt lgkmcnt(6)
  v_mfma_f32_32x32x16_bf16 v[160:175], a[140:143], a[132:135], v[160:175]
  ds_read_b64_tr_b16 a[160:161], v54 offset:40960
  ds_read_b64_tr_b16 a[162:163], v54 offset:41472
  ds_read_b128 a[164:167], v49 offset:24576
  s_add_u32 m0, s61, 81920
  s_xor_b32 s5, s99, 49152
  buffer_load_dwordx4 v3, s[44:47], s5 offen offset:0 sc1 lds
  v_mfma_f32_32x32x16_bf16 v[176:191], a[140:143], a[136:139], v[176:191]
  ds_read_b128 a[168:171], v49 offset:25600
  s_add_u32 m0, s61, 86016
  s_xor_b32 s5, s99, 50176
  buffer_load_dwordx4 v3, s[44:47], s5 offen offset:0 sc1 lds
  buffer_load_dword v13, v6, s[44:47], 0 offen sc1
  s_waitcnt lgkmcnt(6)
  v_mfma_f32_32x32x16_bf16 v[128:143], a[144:147], a[148:151], v[128:143]
  ds_read_b64_tr_b16 a[172:173], v54 offset:45056
  ds_read_b64_tr_b16 a[174:175], v54 offset:45568
  s_mov_b32 s62, 8192
  buffer_load_dwordx2 v[196:197], v215, s[8:11], s62 offen
  v_mfma_f32_32x32x16_bf16 v[144:159], a[144:147], a[152:155], v[144:159]
  s_add_u32 m0, s61, 90112
  s_xor_b32 s5, s99, 51200
  buffer_load_dwordx4 v3, s[44:47], s5 offen offset:0 sc1 lds
  s_waitcnt lgkmcnt(6)
  v_mfma_f32_32x32x16_bf16 v[160:175], a[156:159], a[148:151], v[160:175]
  ds_read_b64_tr_b16 a[176:177], v54 offset:43008
  ds_read_b64_tr_b16 a[178:179], v54 offset:43520
  ds_read_b128 a[180:183], v49 offset:28672
  s_mov_b32 s62, 12288
  buffer_load_dwordx2 v[198:199], v215, s[8:11], s62 offen
  v_mfma_f32_32x32x16_bf16 v[176:191], a[156:159], a[152:155], v[176:191]
  ds_read_b128 a[184:187], v49 offset:29696
  s_add_u32 m0, s61, 94208
  s_xor_b32 s5, s99, 52224
  buffer_load_dwordx4 v3, s[44:47], s5 offen offset:0 sc1 lds
  s_waitcnt lgkmcnt(6)
  v_mfma_f32_32x32x16_bf16 v[128:143], a[160:163], a[164:167], v[128:143]
  ds_read_b64_tr_b16 a[188:189], v54 offset:47104
  ds_read_b64_tr_b16 a[190:191], v54 offset:47616
  s_lshl_b32 s62, s57, 1
  s_and_b32 s63, s56, 1
  s_add_u32 s62, s62, s63
  s_lshl_b32 s62, s62, 8
  s_add_u32 s62, s62, 16842752
  v_lshlrev_b32 v212, 2, v36
  v_mfma_f32_32x32x16_bf16 v[144:159], a[160:163], a[168:171], v[144:159]
  buffer_load_dword v208, v212, s[44:47], s62 offen sc1
  buffer_load_dword v209, v212, s[44:47], s62 offen offset:128 sc1
  s_waitcnt lgkmcnt(6)
  v_mfma_f32_32x32x16_bf16 v[160:175], a[172:175], a[164:167], v[160:175]
  s_waitcnt vmcnt(16)
  s_barrier
  ds_read_b64_tr_b16 a[128:129], v55 offset:0
  ds_read_b64_tr_b16 a[130:131], v55 offset:512
  s_add_u32 m0, s61, 131072
  ds_read_b128 a[132:135], v49 offset:49152
  buffer_load_dwordx4 v1, s[36:39], s66 offen offset:0 lds
  v_mfma_f32_32x32x16_bf16 v[176:191], a[172:175], a[168:171], v[176:191]
  s_add_u32 m0, s61, 135104
  ds_read_b128 a[136:139], v49 offset:50176
  buffer_load_dwordx4 v1, s[36:39], s66 offen offset:64 lds
  v_and_b32 v212, 7, v36
  s_waitcnt lgkmcnt(6)
  v_mfma_f32_32x32x16_bf16 v[128:143], a[176:179], a[180:183], v[128:143]
  ds_read_b64_tr_b16 a[140:141], v55 offset:4096
  ds_read_b64_tr_b16 a[142:143], v55 offset:4608
  v_xor_b32 v212, v212, v37
  v_lshlrev_b32 v212, 4, v212
  v_lshl_add_u32 v212, v36, 7, v212
  s_lshl_b32 s62, s56, 12
  v_add_u32 v212, s62, v212
  v_xor_b32 v213, v221, v220
  v_lshlrev_b32 v213, 4, v213
  s_add_u32 m0, s61, 139264
  v_mfma_f32_32x32x16_bf16 v[144:159], a[176:179], a[184:187], v[144:159]
  buffer_load_dwordx4 v1, s[36:39], s67 offen offset:0 lds
  v_lshl_add_u32 v213, v220, 7, v213
  v_add_u32 v213, s62, v213
  s_waitcnt lgkmcnt(6)
  v_mfma_f32_32x32x16_bf16 v[160:175], a[188:191], a[180:183], v[160:175]
  ds_read_b64_tr_b16 a[144:145], v55 offset:2048
  ds_read_b64_tr_b16 a[146:147], v55 offset:2560
  ds_read_b128 a[148:151], v49 offset:53248
  v_mfma_f32_32x32x16_bf16 v[176:191], a[188:191], a[184:187], v[176:191]
  s_add_u32 m0, s61, 143296
  ds_read_b128 a[152:155], v49 offset:54272
  buffer_load_dwordx4 v1, s[36:39], s67 offen offset:64 lds
  s_waitcnt lgkmcnt(6)
  v_mfma_f32_32x32x16_bf16 v[128:143], a[128:131], a[132:135], v[128:143]
  ds_read_b64_tr_b16 a[156:157], v55 offset:6144
  ds_read_b64_tr_b16 a[158:159], v55 offset:6656
  v_mfma_f32_32x32x16_bf16 v[144:159], a[128:131], a[136:139], v[144:159]
  s_waitcnt lgkmcnt(6)
  v_mfma_f32_32x32x16_bf16 v[160:175], a[140:143], a[132:135], v[160:175]
  ds_read_b64_tr_b16 a[160:161], v55 offset:8192
  ds_read_b64_tr_b16 a[162:163], v55 offset:8704
  ds_read_b128 a[164:167], v49 offset:57344
  v_mfma_f32_32x32x16_bf16 v[176:191], a[140:143], a[136:139], v[176:191]
  ds_read_b128 a[168:171], v49 offset:58368
  s_waitcnt lgkmcnt(6)
  v_mfma_f32_32x32x16_bf16 v[128:143], a[144:147], a[148:151], v[128:143]
  ds_read_b64_tr_b16 a[172:173], v55 offset:12288
  ds_read_b64_tr_b16 a[174:175], v55 offset:12800
  v_mfma_f32_32x32x16_bf16 v[144:159], a[144:147], a[152:155], v[144:159]
  s_waitcnt lgkmcnt(6)
  v_mfma_f32_32x32x16_bf16 v[160:175], a[156:159], a[148:151], v[160:175]
  ds_read_b64_tr_b16 a[176:177], v55 offset:10240
  ds_read_b64_tr_b16 a[178:179], v55 offset:10752
  ds_read_b128 a[180:183], v49 offset:61440
  v_mfma_f32_32x32x16_bf16 v[176:191], a[156:159], a[152:155], v[176:191]
  ds_read_b128 a[184:187], v49 offset:62464
  s_waitcnt vmcnt(10)
  v_cmp_gt_u32 vcc, 3, v13
  s_nop 0
  s_cbranch_vccz SPD4
  s_mov_b32 s6, 0
SP4:
  buffer_load_dword v13, v6, s[44:47], 0 offen sc1
  s_add_u32 s6, s6, 1
  s_waitcnt vmcnt(0)
  s_cmp_gt_u32 s6, 300000
  s_cbranch_scc1 SPD4
  v_cmp_gt_u32 vcc, 3, v13
  s_nop 0
  s_cbranch_vccnz SP4
SPD4:
  s_waitcnt lgkmcnt(6)
  v_mfma_f32_32x32x16_bf16 v[128:143], a[160:163], a[164:167], v[128:143]
  ds_read_b64_tr_b16 a[188:189], v55 offset:14336
  ds_read_b64_tr_b16 a[190:191], v55 offset:14848
  s_add_u32 m0, s61, 114688
  s_xor_b32 s5, s99, 4096
  buffer_load_dwordx4 v3, s[44:47], s5 offen offset:0 sc1 lds
  v_mfma_f32_32x32x16_bf16 v[144:159], a[160:163], a[168:171], v[144:159]
  s_add_u32 m0, s61, 118784
  s_xor_b32 s5, s99, 5120
  buffer_load_dwordx4 v3, s[44:47], s5 offen offset:0 sc1 lds
  s_waitcnt lgkmcnt(6)
  v_mfma_f32_32x32x16_bf16 v[160:175], a[172:175], a[164:167], v[160:175]
  s_waitcnt vmcnt(8)
  s_barrier
  ds_read_b64_tr_b16 a[128:129], v55 offset:32768
  ds_read_b64_tr_b16 a[130:131], v55 offset:33280
  ds_read_b128 a[132:135], v51 offset:16384
  v_mfma_f32_32x32x16_bf16 v[176:191], a[172:175], a[168:171], v[176:191]
  ds_read_b128 a[136:139], v51 offset:17408
  s_add_u32 m0, s61, 122880
  s_xor_b32 s5, s99, 20480
  buffer_load_dwordx4 v3, s[44:47], s5 offen offset:0 sc1 lds
  s_waitcnt lgkmcnt(6)
  v_mfma_f32_32x32x16_bf16 v[128:143], a[176:179], a[180:183], v[128:143]
  ds_read_b64_tr_b16 a[140:141], v55 offset:36864
  ds_read_b64_tr_b16 a[142:143], v55 offset:37376
  v_mfma_f32_32x32x16_bf16 v[144:159], a[176:179], a[184:187], v[144:159]
  s_add_u32 m0, s61, 126976
  s_xor_b32 s5, s99, 21504
  buffer_load_dwordx4 v3, s[44:47], s5 offen offset:0 sc1 lds
  s_waitcnt lgkmcnt(6)
  v_mfma_f32_32x32x16_bf16 v[160:175], a[188:191], a[180:183], v[160:175]
  ds_read_b64_tr_b16 a[144:145], v55 offset:34816
  ds_read_b64_tr_b16 a[146:147], v55 offset:35328
  ds_read_b128 a[148:151], v51 offset:20480
  s_waitcnt vmcnt(9)
  v_sub_f32 v210, 1.0, v208
  v_cvt_pk_bf16_f32 v210, v210, v210
  v_lshlrev_b32 v210, 16, v210
  s_waitcnt vmcnt(8)
  v_sub_f32 v211, 1.0, v209
  v_mfma_f32_32x32x16_bf16 v[176:191], a[188:191], a[184:187], v[176:191]
  s_add_u32 m0, s61, 16384
  ds_read_b128 a[152:155], v51 offset:21504
  buffer_load_dwordx4 v1, s[36:39], s68 offen offset:0 lds
  s_waitcnt lgkmcnt(6)
  v_mfma_f32_32x32x16_bf16 v[128:143], a[128:131], a[132:135], v[128:143]
  ds_read_b64_tr_b16 a[156:157], v55 offset:38912
  s_add_u32 m0, s61, 20416
  ds_read_b64_tr_b16 a[158:159], v55 offset:39424
  buffer_load_dwordx4 v1, s[36:39], s68 offen offset:64 lds
  v_mfma_f32_32x32x16_bf16 v[144:159], a[128:131], a[136:139], v[144:159]
  v_cvt_pk_bf16_f32 v211, v211, v211
  v_lshlrev_b32 v211, 16, v211
  v_lshlrev_b32 v216, 16, v204
  v_and_b32 v217, 0xffff0000, v204
  v_lshlrev_b32 v218, 16, v205
  v_and_b32 v219, 0xffff0000, v205
  v_lshlrev_b32 v220, 16, v192
  s_waitcnt lgkmcnt(6)
  v_mfma_f32_32x32x16_bf16 v[160:175], a[140:143], a[132:135], v[160:175]
  ds_read_b64_tr_b16 a[160:161], v55 offset:40960
  ds_read_b64_tr_b16 a[162:163], v55 offset:41472
  s_add_u32 m0, s61, 24576
  ds_read_b128 a[164:167], v51 offset:24576
  buffer_load_dwordx4 v1, s[36:39], s69 offen offset:0 lds
  v_mfma_f32_32x32x16_bf16 v[176:191], a[140:143], a[136:139], v[176:191]
  ds_read_b128 a[168:171], v51 offset:25600
  v_and_b32 v221, 0xffff0000, v192
  v_mul_f32 v220, v220, v216
  v_mul_f32 v221, v221, v217
  v_cvt_pk_bf16_f32 v220, v220, v221
  v_and_b32 v221, 0xffff0000, v220
  v_lshlrev_b32 v220, 16, v220
  s_waitcnt lgkmcnt(6)
  v_mfma_f32_32x32x16_bf16 v[128:143], a[144:147], a[148:151], v[128:143]
  ds_read_b64_tr_b16 a[172:173], v55 offset:45056
  s_add_u32 m0, s61, 28608
  ds_read_b64_tr_b16 a[174:175], v55 offset:45568
  buffer_load_dwordx4 v1, s[36:39], s69 offen offset:64 lds
  v_mfma_f32_32x32x16_bf16 v[144:159], a[144:147], a[152:155], v[144:159]
  v_mul_f32 v240, v220, v200
  v_mul_f32 v241, v221, v200
  v_lshlrev_b32 v220, 16, v193
  v_and_b32 v221, 0xffff0000, v193
  v_mul_f32 v220, v220, v218
  v_mul_f32 v221, v221, v219
  v_cvt_pk_bf16_f32 v220, v220, v221
  s_waitcnt lgkmcnt(6)
  v_mfma_f32_32x32x16_bf16 v[160:175], a[156:159], a[148:151], v[160:175]
  ds_read_b64_tr_b16 a[176:177], v55 offset:43008
  ds_read_b64_tr_b16 a[178:179], v55 offset:43520
  ds_read_b128 a[180:183], v51 offset:28672
  s_add_u32 m0, s61, 147456
  s_xor_b32 s5, s99, 36864
  buffer_load_dwordx4 v3, s[44:47], s5 offen offset:0 sc1 lds
  v_mfma_f32_32x32x16_bf16 v[176:191], a[156:159], a[152:155], v[176:191]
  ds_read_b128 a[184:187], v51 offset:29696
  s_add_u32 m0, s61, 151552
  s_xor_b32 s5, s99, 37888
  buffer_load_dwordx4 v3, s[44:47], s5 offen offset:0 sc1 lds
  s_waitcnt lgkmcnt(6)
  v_mfma_f32_32x32x16_bf16 v[128:143], a[160:163], a[164:167], v[128:143]
  ds_read_b64_tr_b16 a[188:189], v55 offset:47104
  ds_read_b64_tr_b16 a[190:191], v55 offset:47616
  v_and_b32 v221, 0xffff0000, v220
  v_lshlrev_b32 v220, 16, v220
  v_mul_f32 v242, v220, v200
  v_mul_f32 v243, v221, v200
  v_mfma_f32_32x32x16_bf16 v[144:159], a[160:163], a[168:171], v[144:159]
  s_add_u32 m0, s61, 155648
  s_xor_b32 s5, s99, 53248
  buffer_load_dwordx4 v3, s[44:47], s5 offen offset:0 sc1 lds
  v_lshlrev_b32 v220, 16, v194
  s_waitcnt lgkmcnt(6)
  v_mfma_f32_32x32x16_bf16 v[160:175], a[172:175], a[164:167], v[160:175]
  s_waitcnt vmcnt(7)
  s_barrier
  ds_read_b64_tr_b16 a[128:129], v53 offset:0
  ds_read_b64_tr_b16 a[130:131], v53 offset:512
  ds_read_b128 a[132:135], v51 offset:49152
  v_mfma_f32_32x32x16_bf16 v[176:191], a[172:175], a[168:171], v[176:191]
  ds_read_b128 a[136:139], v51 offset:50176
  s_add_u32 m0, s61, 159744
  s_xor_b32 s5, s99, 54272
  buffer_load_dwordx4 v3, s[44:47], s5 offen offset:0 sc1 lds
  s_waitcnt lgkmcnt(6)
  v_mfma_f32_32x32x16_bf16 v[128:143], a[176:179], a[180:183], v[128:143]
  ds_read_b64_tr_b16 a[140:141], v53 offset:4096
  ds_read_b64_tr_b16 a[142:143], v53 offset:4608
  v_and_b32 v221, 0xffff0000, v194
  v_mul_f32 v220, v220, v216
  v_mul_f32 v221, v221, v217
  v_cvt_pk_bf16_f32 v220, v220, v221
  v_and_b32 v221, 0xffff0000, v220
  s_add_u32 m0, s61, 49152
  v_mfma_f32_32x32x16_bf16 v[144:159], a[176:179], a[184:187], v[144:159]
  buffer_load_dwordx4 v4, s[36:39], s78 offen offset:0 lds
  v_lshlrev_b32 v220, 16, v220
  s_waitcnt lgkmcnt(6)
  v_mfma_f32_32x32x16_bf16 v[160:175], a[188:191], a[180:183], v[160:175]
  ds_read_b64_tr_b16 a[144:145], v53 offset:2048
  ds_read_b64_tr_b16 a[146:147], v53 offset:2560
  s_add_u32 m0, s61, 53184
  ds_read_b128 a[148:151], v51 offset:53248
  buffer_load_dwordx4 v4, s[36:39], s78 offen offset:64 lds
  v_mfma_f32_32x32x16_bf16 v[176:191], a[188:191], a[184:187], v[176:191]
  ds_read_b128 a[152:155], v51 offset:54272
  v_mul_f32 v244, v220, v201
  v_mul_f32 v245, v221, v201
  v_lshlrev_b32 v220, 16, v195
  v_and_b32 v221, 0xffff0000, v195
  v_mul_f32 v220, v220, v218
  v_mul_f32 v221, v221, v219
  s_waitcnt lgkmcnt(6)
  v_mfma_f32_32x32x16_bf16 v[128:143], a[128:131], a[132:135], v[128:143]
  ds_read_b64_tr_b16 a[156:157], v53 offset:6144
  s_add_u32 m0, s61, 57344
  ds_read_b64_tr_b16 a[158:159], v53 offset:6656
  buffer_load_dwordx4 v4, s[36:39], s90 offen offset:0 lds
  v_mfma_f32_32x32x16_bf16 v[144:159], a[128:131], a[136:139], v[144:159]
  v_cvt_pk_bf16_f32 v220, v220, v221
  v_and_b32 v221, 0xffff0000, v220
  v_lshlrev_b32 v220, 16, v220
  v_mul_f32 v246, v220, v201
  v_mul_f32 v247, v221, v201
  v_lshlrev_b32 v220, 16, v196
  v_and_b32 v221, 0xffff0000, v196
  s_waitcnt lgkmcnt(6)
  v_mfma_f32_32x32x16_bf16 v[160:175], a[140:143], a[132:135], v[160:175]
  ds_read_b64_tr_b16 a[160:161], v53 offset:8192
  ds_read_b64_tr_b16 a[162:163], v53 offset:8704
  s_add_u32 m0, s61, 61376
  ds_read_b128 a[164:167], v51 offset:57344
  buffer_load_dwordx4 v4, s[36:39], s90 offen offset:64 lds
  v_mfma_f32_32x32x16_bf16 v[176:191], a[140:143], a[136:139], v[176:191]
  ds_read_b128 a[168:171], v51 offset:58368
  v_mul_f32 v220, v220, v216
  v_mul_f32 v221, v221, v217
  v_cvt_pk_bf16_f32 v220, v220, v221
  v_and_b32 v221, 0xffff0000, v220
  v_lshlrev_b32 v220, 16, v220
  s_waitcnt lgkmcnt(6)
  v_mfma_f32_32x32x16_bf16 v[128:143], a[144:147], a[148:151], v[128:143]
  ds_read_b64_tr_b16 a[172:173], v53 offset:12288
  ds_read_b64_tr_b16 a[174:175], v53 offset:12800
  s_add_u32 m0, s61, 32768
  s_xor_b32 s5, s99, 6144
  buffer_load_dwordx4 v3, s[44:47], s5 offen offset:0 sc1 lds
  v_mfma_f32_32x32x16_bf16 v[144:159], a[144:147], a[152:155], v[144:159]
  s_add_u32 m0, s61, 36864
  s_xor_b32 s5, s99, 22528
  buffer_load_dwordx4 v3, s[44:47], s5 offen offset:0 sc1 lds
  v_mul_f32 v248, v220, v202
  s_waitcnt lgkmcnt(6)
  v_mfma_f32_32x32x16_bf16 v[160:175], a[156:159], a[148:151], v[160:175]
  ds_read_b64_tr_b16 a[176:177], v53 offset:10240
  ds_read_b64_tr_b16 a[178:179], v53 offset:10752
  ds_read_b128 a[180:183], v51 offset:61440
  v_mul_f32 v249, v221, v202
  v_lshlrev_b32 v220, 16, v197
  v_and_b32 v221, 0xffff0000, v197
  v_mul_f32 v220, v220, v218
  v_mfma_f32_32x32x16_bf16 v[176:191], a[156:159], a[152:155], v[176:191]
  ds_read_b128 a[184:187], v51 offset:62464
  s_add_u32 m0, s61, 40960
  s_xor_b32 s5, s99, 38912
  buffer_load_dwordx4 v3, s[44:47], s5 offen offset:0 sc1 lds
  s_waitcnt lgkmcnt(6)
  v_mfma_f32_32x32x16_bf16 v[128:143], a[160:163], a[164:167], v[128:143]
  ds_read_b64_tr_b16 a[188:189], v53 offset:14336
  ds_read_b64_tr_b16 a[190:191], v53 offset:14848
  v_mul_f32 v221, v221, v219
  v_cvt_pk_bf16_f32 v220, v220, v221
  v_and_b32 v221, 0xffff0000, v220
  v_lshlrev_b32 v220, 16, v220
  v_mul_f32 v250, v220, v202
  v_mfma_f32_32x32x16_bf16 v[144:159], a[160:163], a[168:171], v[144:159]
  s_add_u32 m0, s61, 45056
  s_xor_b32 s5, s99, 55296
  buffer_load_dwordx4 v3, s[44:47], s5 offen offset:0 sc1 lds
  s_waitcnt lgkmcnt(6)
  v_mfma_f32_32x32x16_bf16 v[160:175], a[172:175], a[164:167], v[160:175]
  s_waitcnt vmcnt(8)
  s_barrier
  ds_read_b64_tr_b16 a[128:129], v54 offset:16384
  ds_read_b64_tr_b16 a[130:131], v54 offset:16896
  ds_read_b128 a[132:135], v47 offset:16384
  v_mfma_f32_32x32x16_bf16 v[176:191], a[172:175], a[168:171], v[176:191]
  ds_read_b128 a[136:139], v47 offset:17408
  v_mul_f32 v251, v221, v202
  v_lshlrev_b32 v220, 16, v198
  v_and_b32 v221, 0xffff0000, v198
  v_mul_f32 v220, v220, v216
  v_mul_f32 v221, v221, v217
  v_cvt_pk_bf16_f32 v220, v220, v221
  s_waitcnt lgkmcnt(6)
  v_mfma_f32_32x32x16_bf16 v[128:143], a[176:179], a[180:183], v[128:143]
  ds_read_b64_tr_b16 a[140:141], v54 offset:20480
  ds_read_b64_tr_b16 a[142:143], v54 offset:20992
  v_and_b32 v221, 0xffff0000, v220
  v_lshlrev_b32 v220, 16, v220
  v_mul_f32 v252, v220, v203
  v_mul_f32 v253, v221, v203
  v_lshlrev_b32 v220, 16, v199
  v_mfma_f32_32x32x16_bf16 v[144:159], a[176:179], a[184:187], v[144:159]
  v_and_b32 v221, 0xffff0000, v199
  v_mul_f32 v220, v220, v218
  v_mul_f32 v221, v221, v219
  v_cvt_pk_bf16_f32 v220, v220, v221
  v_and_b32 v221, 0xffff0000, v220
  v_lshlrev_b32 v220, 16, v220
  v_mul_f32 v254, v220, v203
  s_waitcnt lgkmcnt(6)
  v_mfma_f32_32x32x16_bf16 v[160:175], a[188:191], a[180:183], v[160:175]
  ds_read_b64_tr_b16 a[144:145], v54 offset:18432
  ds_read_b64_tr_b16 a[146:147], v54 offset:18944
  ds_read_b128 a[148:151], v47 offset:20480
  v_mul_f32 v255, v221, v203
  v_mul_f32 v64, v64, v208
  v_mul_f32 v65, v65, v208
  v_mfma_f32_32x32x16_bf16 v[176:191], a[188:191], a[184:187], v[176:191]
  ds_read_b128 a[152:155], v47 offset:21504
  v_mul_f32 v66, v66, v208
  v_mul_f32 v67, v67, v208
  v_mul_f32 v68, v68, v208
  v_mul_f32 v69, v69, v208
  v_mul_f32 v70, v70, v208
  v_mul_f32 v71, v71, v208
  s_waitcnt lgkmcnt(6)
  v_mfma_f32_32x32x16_bf16 v[128:143], a[128:131], a[132:135], v[128:143]
  ds_read_b64_tr_b16 a[156:157], v54 offset:22528
  ds_read_b64_tr_b16 a[158:159], v54 offset:23040
  v_mul_f32 v72, v72, v208
  v_mul_f32 v73, v73, v208
  v_mul_f32 v74, v74, v208
  v_mul_f32 v75, v75, v208
  v_mul_f32 v76, v76, v208
  v_mfma_f32_32x32x16_bf16 v[144:159], a[128:131], a[136:139], v[144:159]
  v_mul_f32 v77, v77, v208
  v_mul_f32 v78, v78, v208
  v_mul_f32 v79, v79, v208
  v_mul_f32 v80, v80, v209
  v_mul_f32 v81, v81, v209
  v_mul_f32 v82, v82, v209
  v_mul_f32 v83, v83, v209
  s_waitcnt lgkmcnt(6)
  v_mfma_f32_32x32x16_bf16 v[160:175], a[140:143], a[132:135], v[160:175]
  ds_read_b64_tr_b16 a[160:161], v54 offset:24576
  ds_read_b64_tr_b16 a[162:163], v54 offset:25088
  ds_read_b128 a[164:167], v47 offset:24576
  v_mul_f32 v84, v84, v209
  v_mul_f32 v85, v85, v209
  v_mul_f32 v86, v86, v209
  v_mul_f32 v87, v87, v209
  v_mfma_f32_32x32x16_bf16 v[176:191], a[140:143], a[136:139], v[176:191]
  ds_read_b128 a[168:171], v47 offset:25600
  v_mul_f32 v88, v88, v209
  v_mul_f32 v89, v89, v209
  v_mul_f32 v90, v90, v209
  v_mul_f32 v91, v91, v209
  v_mul_f32 v92, v92, v209
  v_mul_f32 v93, v93, v209
  s_waitcnt lgkmcnt(6)
  v_mfma_f32_32x32x16_bf16 v[128:143], a[144:147], a[148:151], v[128:143]
  ds_read_b64_tr_b16 a[172:173], v54 offset:28672
  ds_read_b64_tr_b16 a[174:175], v54 offset:29184
  v_mul_f32 v94, v94, v209
  v_mul_f32 v95, v95, v209
  v_mul_f32 v96, v96, v208
  v_mul_f32 v97, v97, v208
  v_mul_f32 v98, v98, v208
  v_mfma_f32_32x32x16_bf16 v[144:159], a[144:147], a[152:155], v[144:159]
  v_mul_f32 v99, v99, v208
  v_mul_f32 v100, v100, v208
  v_mul_f32 v101, v101, v208
  v_mul_f32 v102, v102, v208
  v_mul_f32 v103, v103, v208
  v_mul_f32 v104, v104, v208
  v_mul_f32 v105, v105, v208
  s_waitcnt lgkmcnt(6)
  v_mfma_f32_32x32x16_bf16 v[160:175], a[156:159], a[148:151], v[160:175]
  ds_read_b64_tr_b16 a[176:177], v54 offset:26624
  ds_read_b64_tr_b16 a[178:179], v54 offset:27136
  ds_read_b128 a[180:183], v47 offset:28672
  v_mul_f32 v106, v106, v208
  v_mul_f32 v107, v107, v208
  v_mul_f32 v108, v108, v208
  v_mfma_f32_32x32x16_bf16 v[176:191], a[156:159], a[152:155], v[176:191]
  ds_read_b128 a[184:187], v47 offset:29696
  v_mul_f32 v109, v109, v208
  v_mul_f32 v110, v110, v208
  v_mul_f32 v111, v111, v208
  v_mul_f32 v112, v112, v209
  v_mul_f32 v113, v113, v209
  v_mul_f32 v114, v114, v209
  s_waitcnt lgkmcnt(6)
  v_mfma_f32_32x32x16_bf16 v[128:143], a[160:163], a[164:167], v[128:143]
  ds_read_b64_tr_b16 a[188:189], v54 offset:30720
  ds_read_b64_tr_b16 a[190:191], v54 offset:31232
  v_mul_f32 v115, v115, v209
  v_mul_f32 v116, v116, v209
  v_mul_f32 v117, v117, v209
  v_mul_f32 v118, v118, v209
  v_mul_f32 v119, v119, v209
  v_mfma_f32_32x32x16_bf16 v[144:159], a[160:163], a[168:171], v[144:159]
  v_mul_f32 v120, v120, v209
  v_mul_f32 v121, v121, v209
  v_mul_f32 v122, v122, v209
  v_mul_f32 v123, v123, v209
  v_mul_f32 v124, v124, v209
  v_mul_f32 v125, v125, v209
  v_mul_f32 v126, v126, v209
  s_waitcnt lgkmcnt(6)
  v_mfma_f32_32x32x16_bf16 v[160:175], a[172:175], a[164:167], v[160:175]
  s_waitcnt vmcnt(0)
  s_barrier
  ds_read_b64_tr_b16 a[128:129], v54 offset:49152
  ds_read_b64_tr_b16 a[130:131], v54 offset:49664
  ds_read_b128 a[132:135], v49 offset:32768
  v_mfma_f32_32x32x16_bf16 v[176:191], a[172:175], a[168:171], v[176:191]
  ds_read_b64_tr_b16 a[136:137], v54 offset:51200
  ds_read_b64_tr_b16 a[138:139], v54 offset:51712
  ds_read_b128 a[140:143], v49 offset:36864
  v_mul_f32 v127, v127, v209
  v_xor_b32 v225, 32, v212
  v_xor_b32 v226, 64, v212
  v_xor_b32 v227, 96, v212
  s_waitcnt lgkmcnt(8)
  v_mfma_f32_32x32x16_bf16 v[128:143], a[176:179], a[180:183], v[128:143]
  ds_read_b64_tr_b16 a[144:145], v54 offset:57344
  ds_read_b64_tr_b16 a[146:147], v54 offset:57856
  ds_read_b128 a[148:151], v49 offset:40960
  v_lshlrev_b32 v228, 4, v35
  v_add_u32 v228, 65536, v228
  s_lshl_b32 s62, s56, 12
  v_add_u32 v229, s62, v228
  v_mfma_f32_32x32x16_bf16 v[144:159], a[176:179], a[184:187], v[144:159]
  ds_read_b64_tr_b16 a[152:153], v54 offset:59392
  ds_read_b64_tr_b16 a[154:155], v54 offset:59904
  ds_read_b128 a[156:159], v49 offset:45056
  s_waitcnt lgkmcnt(12)
  v_mfma_f32_32x32x16_bf16 v[160:175], a[188:191], a[180:183], v[160:175]
  ds_read_b128 a[160:163], v49 offset:33792
  s_add_u32 s66, s59, 1
  s_and_b32 s66, s66, 3
  s_lshl_b32 s66, s66, 13
  s_add_u32 s67, s59, 2
  s_and_b32 s67, s67, 3
  s_lshl_b32 s67, s67, 13
  v_mfma_f32_32x32x16_bf16 v[176:191], a[188:191], a[184:187], v[176:191]
  ds_read_b128 a[164:167], v49 offset:37888
  s_add_u32 s68, s59, 3
  s_and_b32 s68, s68, 3
  s_lshl_b32 s68, s68, 13
  s_waitcnt lgkmcnt(8)
  v_mfma_f32_32x32x16_bf16 v[128:143], a[128:131], a[132:135], v[128:143]
  ds_read_b128 a[168:171], v49 offset:41984
  s_add_u32 s69, s59, 4
  s_and_b32 s69, s69, 3
  s_lshl_b32 s69, s69, 13
  v_mfma_f32_32x32x16_bf16 v[128:143], a[136:139], a[140:143], v[128:143]
  ds_read_b128 a[172:175], v49 offset:46080
  ds_read_b64_tr_b16 a[176:177], v54 offset:53248
  ds_read_b64_tr_b16 a[178:179], v54 offset:53760
  ds_read_b64_tr_b16 a[180:181], v54 offset:55296
  ds_read_b64_tr_b16 a[182:183], v54 offset:55808
  ds_read_b64_tr_b16 a[184:185], v54 offset:61440
  ds_read_b64_tr_b16 a[186:187], v54 offset:61952
  ds_read_b64_tr_b16 a[188:189], v54 offset:63488
  ds_read_b64_tr_b16 a[190:191], v54 offset:64000
  s_waitcnt lgkmcnt(15)
  v_mfma_f32_32x32x16_bf16 v[128:143], a[144:147], a[148:151], v[128:143]
  s_waitcnt lgkmcnt(0)
  s_cmp_eq_u32 s56, s59
  s_cbranch_scc1 OWNQ
  v_mfma_f32_32x32x16_bf16 v[128:143], a[152:155], a[156:159], v[128:143]
  v_mfma_f32_32x32x16_bf16 v[144:159], a[128:131], a[160:163], v[144:159]
  v_mfma_f32_32x32x16_bf16 v[144:159], a[136:139], a[164:167], v[144:159]
  s_nop 9
  v_fmac_f32 v64, v128, v210
  v_fmac_f32 v65, v129, v210
  v_fmac_f32 v66, v130, v210
  v_fmac_f32 v67, v131, v210
  v_fmac_f32 v68, v132, v210
  v_fmac_f32 v69, v133, v210
  v_fmac_f32 v70, v134, v210
  v_fmac_f32 v71, v135, v210
  v_mfma_f32_32x32x16_bf16 v[144:159], a[144:147], a[168:171], v[144:159]
  v_cvt_pk_bf16_f32 v64, v64, v65
  v_cvt_pk_bf16_f32 v65, v66, v67
  v_cvt_pk_bf16_f32 v66, v68, v69
  v_cvt_pk_bf16_f32 v67, v70, v71
  buffer_store_dwordx4 v[64:67], v41, s[44:47], 0 offen offset:0 sc1
  v_fmac_f32 v72, v136, v210
  v_fmac_f32 v73, v137, v210
  v_fmac_f32 v74, v138, v210
  v_fmac_f32 v75, v139, v210
  v_mfma_f32_32x32x16_bf16 v[144:159], a[152:155], a[172:175], v[144:159]
  v_fmac_f32 v76, v140, v210
  v_fmac_f32 v77, v141, v210
  v_fmac_f32 v78, v142, v210
  v_fmac_f32 v79, v143, v210
  v_cvt_pk_bf16_f32 v72, v72, v73
  v_cvt_pk_bf16_f32 v73, v74, v75
  v_cvt_pk_bf16_f32 v74, v76, v77
  v_cvt_pk_bf16_f32 v75, v78, v79
  buffer_store_dwordx4 v[72:75], v41, s[44:47], 0 offen offset:1024 sc1
  v_mfma_f32_32x32x16_bf16 v[160:175], a[176:179], a[132:135], v[160:175]
  v_mfma_f32_32x32x16_bf16 v[160:175], a[180:183], a[140:143], v[160:175]
  s_nop 0
  v_fmac_f32 v80, v144, v211
  v_fmac_f32 v81, v145, v211
  v_fmac_f32 v82, v146, v211
  v_fmac_f32 v83, v147, v211
  v_fmac_f32 v84, v148, v211
  v_fmac_f32 v85, v149, v211
  v_fmac_f32 v86, v150, v211
  v_fmac_f32 v87, v151, v211
  v_mfma_f32_32x32x16_bf16 v[160:175], a[184:187], a[148:151], v[160:175]
  v_cvt_pk_bf16_f32 v80, v80, v81
  v_cvt_pk_bf16_f32 v81, v82, v83
  v_cvt_pk_bf16_f32 v82, v84, v85
  v_cvt_pk_bf16_f32 v83, v86, v87
  buffer_store_dwordx4 v[80:83], v41, s[44:47], 0 offen offset:2048 sc1
  v_fmac_f32 v88, v152, v211
  v_fmac_f32 v89, v153, v211
  v_fmac_f32 v90, v154, v211
  v_fmac_f32 v91, v155, v211
  v_mfma_f32_32x32x16_bf16 v[160:175], a[188:191], a[156:159], v[160:175]
  v_fmac_f32 v92, v156, v211
  v_fmac_f32 v93, v157, v211
  v_fmac_f32 v94, v158, v211
  v_fmac_f32 v95, v159, v211
  v_cvt_pk_bf16_f32 v88, v88, v89
  v_cvt_pk_bf16_f32 v89, v90, v91
  v_cvt_pk_bf16_f32 v90, v92, v93
  v_cvt_pk_bf16_f32 v91, v94, v95
  buffer_store_dwordx4 v[88:91], v41, s[44:47], 0 offen offset:3072 sc1
  v_mfma_f32_32x32x16_bf16 v[176:191], a[176:179], a[160:163], v[176:191]
  v_mfma_f32_32x32x16_bf16 v[176:191], a[180:183], a[164:167], v[176:191]
  s_nop 0
  v_fmac_f32 v96, v160, v210
  v_fmac_f32 v97, v161, v210
  v_fmac_f32 v98, v162, v210
  v_fmac_f32 v99, v163, v210
  v_fmac_f32 v100, v164, v210
  v_fmac_f32 v101, v165, v210
  v_fmac_f32 v102, v166, v210
  v_fmac_f32 v103, v167, v210
  v_mfma_f32_32x32x16_bf16 v[176:191], a[184:187], a[168:171], v[176:191]
  v_cvt_pk_bf16_f32 v96, v96, v97
  v_cvt_pk_bf16_f32 v97, v98, v99
  v_cvt_pk_bf16_f32 v98, v100, v101
  v_cvt_pk_bf16_f32 v99, v102, v103
  buffer_store_dwordx4 v[96:99], v41, s[44:47], s7 offen offset:0 sc1
  v_fmac_f32 v104, v168, v210
  v_fmac_f32 v105, v169, v210
  v_fmac_f32 v106, v170, v210
  v_fmac_f32 v107, v171, v210
  v_mfma_f32_32x32x16_bf16 v[176:191], a[188:191], a[172:175], v[176:191]
  v_fmac_f32 v108, v172, v210
  v_fmac_f32 v109, v173, v210
  v_fmac_f32 v110, v174, v210
  v_fmac_f32 v111, v175, v210
  v_cvt_pk_bf16_f32 v104, v104, v105
  v_cvt_pk_bf16_f32 v105, v106, v107
  v_cvt_pk_bf16_f32 v106, v108, v109
  v_cvt_pk_bf16_f32 v107, v110, v111
  buffer_store_dwordx4 v[104:107], v41, s[44:47], s7 offen offset:1024 sc1
  s_nop 2
  v_fmac_f32 v112, v176, v211
  v_fmac_f32 v113, v177, v211
  v_fmac_f32 v114, v178, v211
  v_fmac_f32 v115, v179, v211
  v_fmac_f32 v116, v180, v211
  v_fmac_f32 v117, v181, v211
  v_fmac_f32 v118, v182, v211
  v_fmac_f32 v119, v183, v211
  v_cvt_pk_bf16_f32 v112, v112, v113
  v_cvt_pk_bf16_f32 v113, v114, v115
  v_cvt_pk_bf16_f32 v114, v116, v117
  v_cvt_pk_bf16_f32 v115, v118, v119
  buffer_store_dwordx4 v[112:115], v41, s[44:47], s7 offen offset:2048 sc1
  v_fmac_f32 v120, v184, v211
  v_fmac_f32 v121, v185, v211
  v_fmac_f32 v122, v186, v211
  v_fmac_f32 v123, v187, v211
  v_fmac_f32 v124, v188, v211
  v_fmac_f32 v125, v189, v211
  v_fmac_f32 v126, v190, v211
  v_fmac_f32 v127, v191, v211
  v_cvt_pk_bf16_f32 v120, v120, v121
  v_cvt_pk_bf16_f32 v121, v122, v123
  v_cvt_pk_bf16_f32 v122, v124, v125
  v_cvt_pk_bf16_f32 v123, v126, v127
  buffer_store_dwordx4 v[120:123], v41, s[44:47], s7 offen offset:3072 sc1
  s_branch JOINQ
OWNQ:
  v_mfma_f32_32x32x16_bf16 v[128:143], a[152:155], a[156:159], v[128:143]
  v_mfma_f32_32x32x16_bf16 v[144:159], a[128:131], a[160:163], v[144:159]
  v_mfma_f32_32x32x16_bf16 v[144:159], a[136:139], a[164:167], v[144:159]
  s_nop 9
  v_fmac_f32 v64, v128, v210
  v_fmac_f32 v65, v129, v210
  v_fmac_f32 v66, v130, v210
  v_fmac_f32 v67, v131, v210
  v_fmac_f32 v68, v132, v210
  v_fmac_f32 v69, v133, v210
  v_mfma_f32_32x32x16_bf16 v[144:159], a[144:147], a[168:171], v[144:159]
  v_fmac_f32 v70, v134, v210
  v_fmac_f32 v71, v135, v210
  ds_write_b128 v228, v[64:67] offset:0
  ds_write_b128 v228, v[68:71] offset:1024
  v_fmac_f32 v72, v136, v210
  v_fmac_f32 v73, v137, v210
  v_fmac_f32 v74, v138, v210
  v_mfma_f32_32x32x16_bf16 v[144:159], a[152:155], a[172:175], v[144:159]
  v_fmac_f32 v75, v139, v210
  v_fmac_f32 v76, v140, v210
  v_fmac_f32 v77, v141, v210
  v_fmac_f32 v78, v142, v210
  v_fmac_f32 v79, v143, v210
  ds_write_b128 v228, v[72:75] offset:2048
  ds_write_b128 v228, v[76:79] offset:3072
  v_mfma_f32_32x32x16_bf16 v[160:175], a[176:179], a[132:135], v[160:175]
  v_mfma_f32_32x32x16_bf16 v[160:175], a[180:183], a[140:143], v[160:175]
  s_nop 2
  v_fmac_f32 v80, v144, v211
  v_fmac_f32 v81, v145, v211
  v_fmac_f32 v82, v146, v211
  v_fmac_f32 v83, v147, v211
  v_fmac_f32 v84, v148, v211
  v_fmac_f32 v85, v149, v211
  v_mfma_f32_32x32x16_bf16 v[160:175], a[184:187], a[148:151], v[160:175]
  v_fmac_f32 v86, v150, v211
  v_fmac_f32 v87, v151, v211
  ds_write_b128 v228, v[80:83] offset:4096
  ds_write_b128 v228, v[84:87] offset:5120
  v_fmac_f32 v88, v152, v211
  v_fmac_f32 v89, v153, v211
  v_fmac_f32 v90, v154, v211
  v_mfma_f32_32x32x16_bf16 v[160:175], a[188:191], a[156:159], v[160:175]
  v_fmac_f32 v91, v155, v211
  v_fmac_f32 v92, v156, v211
  v_fmac_f32 v93, v157, v211
  v_fmac_f32 v94, v158, v211
  v_fmac_f32 v95, v159, v211
  ds_write_b128 v228, v[88:91] offset:6144
  ds_write_b128 v228, v[92:95] offset:7168
  v_mfma_f32_32x32x16_bf16 v[176:191], a[176:179], a[160:163], v[176:191]
  v_mfma_f32_32x32x16_bf16 v[176:191], a[180:183], a[164:167], v[176:191]
  s_nop 2
  v_fmac_f32 v96, v160, v210
  v_fmac_f32 v97, v161, v210
  v_fmac_f32 v98, v162, v210
  v_fmac_f32 v99, v163, v210
  v_fmac_f32 v100, v164, v210
  v_fmac_f32 v101, v165, v210
  v_mfma_f32_32x32x16_bf16 v[176:191], a[184:187], a[168:171], v[176:191]
  v_fmac_f32 v102, v166, v210
  v_fmac_f32 v103, v167, v210
  ds_write_b128 v228, v[96:99] offset:8192
  ds_write_b128 v228, v[100:103] offset:9216
  v_fmac_f32 v104, v168, v210
  v_fmac_f32 v105, v169, v210
  v_fmac_f32 v106, v170, v210
  v_mfma_f32_32x32x16_bf16 v[176:191], a[188:191], a[172:175], v[176:191]
  v_fmac_f32 v107, v171, v210
  v_fmac_f32 v108, v172, v210
  v_fmac_f32 v109, v173, v210
  v_fmac_f32 v110, v174, v210
  v_fmac_f32 v111, v175, v210
  ds_write_b128 v228, v[104:107] offset:10240
  ds_write_b128 v228, v[108:111] offset:11264
  s_nop 4
  v_fmac_f32 v112, v176, v211
  v_fmac_f32 v113, v177, v211
  v_fmac_f32 v114, v178, v211
  v_fmac_f32 v115, v179, v211
  v_fmac_f32 v116, v180, v211
  v_fmac_f32 v117, v181, v211
  v_fmac_f32 v118, v182, v211
  v_fmac_f32 v119, v183, v211
  ds_write_b128 v228, v[112:115] offset:12288
  ds_write_b128 v228, v[116:119] offset:13312
  v_fmac_f32 v120, v184, v211
  v_fmac_f32 v121, v185, v211
  v_fmac_f32 v122, v186, v211
  v_fmac_f32 v123, v187, v211
  v_fmac_f32 v124, v188, v211
  v_fmac_f32 v125, v189, v211
  v_fmac_f32 v126, v190, v211
  v_fmac_f32 v127, v191, v211
  ds_write_b128 v228, v[120:123] offset:14336
  ds_write_b128 v228, v[124:127] offset:15360
  s_waitcnt lgkmcnt(0)
JOINQ:
  s_nop 7
  s_nop 3
  buffer_load_dwordx4 v[128:131], v42, s[44:47], s66 offen offset:0 sc1
  buffer_load_dwordx4 v[132:135], v42, s[44:47], s66 offen offset:1024 sc1
  buffer_load_dwordx4 v[136:139], v42, s[44:47], s67 offen offset:0 sc1
  buffer_load_dwordx4 v[140:143], v42, s[44:47], s67 offen offset:1024 sc1
  buffer_load_dwordx4 v[144:147], v42, s[44:47], s68 offen offset:0 sc1
  buffer_load_dwordx4 v[148:151], v42, s[44:47], s68 offen offset:1024 sc1
  s_barrier
  ds_read_b128 v[64:67], v229 offset:0
  ds_read_b128 v[68:71], v229 offset:1024
  ds_read_b128 v[72:75], v229 offset:2048
  ds_read_b128 v[76:79], v229 offset:3072
  s_waitcnt vmcnt(5)
  v_max3_u32 v13, v128, v129, v130
  s_waitcnt vmcnt(4)
  v_max3_u32 v13, v13, v131, v132
  v_max3_u32 v13, v13, v133, v134
  s_waitcnt vmcnt(3)
  v_max3_u32 v13, v13, v135, v136
  v_max3_u32 v13, v13, v137, v138
  s_waitcnt vmcnt(2)
  v_max3_u32 v13, v13, v139, v140
  v_max3_u32 v13, v13, v141, v142
  s_waitcnt vmcnt(1)
  v_max3_u32 v13, v13, v143, v144
  v_max3_u32 v13, v13, v145, v146
  s_waitcnt vmcnt(0)
  v_max3_u32 v13, v13, v147, v148
  v_max3_u32 v13, v13, v149, v150
  v_max3_u32 v13, v13, v151, v151
  v_cmp_eq_u32 vcc, -1, v13
  s_nop 0
  s_cbranch_vccz SPD6
  s_mov_b32 s6, 0
SP6:
  buffer_load_dwordx4 v[128:131], v42, s[44:47], s66 offen offset:0 sc1
  buffer_load_dwordx4 v[132:135], v42, s[44:47], s66 offen offset:1024 sc1
  buffer_load_dwordx4 v[136:139], v42, s[44:47], s67 offen offset:0 sc1
  buffer_load_dwordx4 v[140:143], v42, s[44:47], s67 offen offset:1024 sc1
  buffer_load_dwordx4 v[144:147], v42, s[44:47], s68 offen offset:0 sc1
  buffer_load_dwordx4 v[148:151], v42, s[44:47], s68 offen offset:1024 sc1
  s_add_u32 s6, s6, 1
  s_waitcnt vmcnt(0)
  s_cmp_gt_u32 s6, 300000
  s_cbranch_scc1 SPD6
  v_max3_u32 v13, v128, v129, v130
  v_max3_u32 v13, v13, v131, v132
  v_max3_u32 v13, v13, v133, v134
  v_max3_u32 v13, v13, v135, v136
  v_max3_u32 v13, v13, v137, v138
  v_max3_u32 v13, v13, v139, v140
  v_max3_u32 v13, v13, v141, v142
  v_max3_u32 v13, v13, v143, v144
  v_max3_u32 v13, v13, v145, v146
  v_max3_u32 v13, v13, v147, v148
  v_max3_u32 v13, v13, v149, v150
  v_max3_u32 v13, v13, v151, v151
  v_cmp_eq_u32 vcc, -1, v13
  s_nop 0
  s_cbranch_vccnz SP6
SPD6:
  v_lshlrev_b32 v80, 16, v128
  v_and_b32 v81, 0xffff0000, v128
  s_waitcnt lgkmcnt(3)
  v_add_f32 v64, v64, v80
  v_add_f32 v65, v65, v81
  v_lshlrev_b32 v82, 16, v129
  v_and_b32 v83, 0xffff0000, v129
  v_add_f32 v66, v66, v82
  v_add_f32 v67, v67, v83
  v_lshlrev_b32 v84, 16, v130
  v_and_b32 v85, 0xffff0000, v130
  s_waitcnt lgkmcnt(2)
  v_add_f32 v68, v68, v84
  v_add_f32 v69, v69, v85
  v_lshlrev_b32 v86, 16, v131
  v_and_b32 v87, 0xffff0000, v131
  v_add_f32 v70, v70, v86
  v_add_f32 v71, v71, v87
  v_lshlrev_b32 v88, 16, v132
  v_and_b32 v89, 0xffff0000, v132
  s_waitcnt lgkmcnt(1)
  v_add_f32 v72, v72, v88
  v_add_f32 v73, v73, v89
  v_lshlrev_b32 v90, 16, v133
  v_and_b32 v91, 0xffff0000, v133
  v_add_f32 v74, v74, v90
  v_add_f32 v75, v75, v91
  v_lshlrev_b32 v92, 16, v134
  v_and_b32 v93, 0xffff0000, v134
  s_waitcnt lgkmcnt(0)
  v_add_f32 v76, v76, v92
  v_add_f32 v77, v77, v93
  v_lshlrev_b32 v94, 16, v135
  v_and_b32 v95, 0xffff0000, v135
  v_add_f32 v78, v78, v94
  v_add_f32 v79, v79, v95
  v_lshlrev_b32 v80, 16, v136
  v_and_b32 v81, 0xffff0000, v136
  v_add_f32 v64, v64, v80
  v_add_f32 v65, v65, v81
  v_lshlrev_b32 v82, 16, v137
  v_and_b32 v83, 0xffff0000, v137
  v_add_f32 v66, v66, v82
  v_add_f32 v67, v67, v83
  v_lshlrev_b32 v84, 16, v138
  v_and_b32 v85, 0xffff0000, v138
  v_add_f32 v68, v68, v84
  v_add_f32 v69, v69, v85
  v_lshlrev_b32 v86, 16, v139
  v_and_b32 v87, 0xffff0000, v139
  v_add_f32 v70, v70, v86
  v_add_f32 v71, v71, v87
  v_lshlrev_b32 v88, 16, v140
  v_and_b32 v89, 0xffff0000, v140
  v_add_f32 v72, v72, v88
  v_add_f32 v73, v73, v89
  v_lshlrev_b32 v90, 16, v141
  v_and_b32 v91, 0xffff0000, v141
  v_add_f32 v74, v74, v90
  v_add_f32 v75, v75, v91
  v_lshlrev_b32 v92, 16, v142
  v_and_b32 v93, 0xffff0000, v142
  v_add_f32 v76, v76, v92
  v_add_f32 v77, v77, v93
  v_lshlrev_b32 v94, 16, v143
  v_and_b32 v95, 0xffff0000, v143
  v_add_f32 v78, v78, v94
  v_add_f32 v79, v79, v95
  v_lshlrev_b32 v80, 16, v144
  v_and_b32 v81, 0xffff0000, v144
  v_add_f32 v64, v64, v80
  v_add_f32 v65, v65, v81
  v_lshlrev_b32 v82, 16, v145
  v_and_b32 v83, 0xffff0000, v145
  v_add_f32 v66, v66, v82
  v_add_f32 v67, v67, v83
  v_lshlrev_b32 v84, 16, v146
  v_and_b32 v85, 0xffff0000, v146
  v_add_f32 v68, v68, v84
  v_add_f32 v69, v69, v85
  v_lshlrev_b32 v86, 16, v147
  v_and_b32 v87, 0xffff0000, v147
  v_add_f32 v70, v70, v86
  v_add_f32 v71, v71, v87
  v_lshlrev_b32 v88, 16, v148
  v_and_b32 v89, 0xffff0000, v148
  v_add_f32 v72, v72, v88
  v_add_f32 v73, v73, v89
  v_lshlrev_b32 v90, 16, v149
  v_and_b32 v91, 0xffff0000, v149
  v_add_f32 v74, v74, v90
  v_add_f32 v75, v75, v91
  v_lshlrev_b32 v92, 16, v150
  v_and_b32 v93, 0xffff0000, v150
  v_add_f32 v76, v76, v92
  v_add_f32 v77, v77, v93
  v_lshlrev_b32 v94, 16, v151
  v_and_b32 v95, 0xffff0000, v151
  v_add_f32 v78, v78, v94
  v_add_f32 v79, v79, v95
  ds_write_b128 v212, v[64:67]
  ds_write_b128 v225, v[68:71]
  ds_write_b128 v226, v[72:75]
  ds_write_b128 v227, v[76:79]
  ds_read_b128 v[96:99], v213 offset:0
  ds_read_b128 v[100:103], v213 offset:1024
  ds_read_b128 v[104:107], v213 offset:2048
  ds_read_b128 v[108:111], v213 offset:3072
  s_waitcnt lgkmcnt(3)
  v_add_f32 v240, v240, v96
  v_add_f32 v241, v241, v97
  v_add_f32 v242, v242, v98
  v_add_f32 v243, v243, v99
  buffer_store_dwordx4 v[240:243], v214, s[40:43], 0 offen sc1
  s_waitcnt lgkmcnt(2)
  v_add_f32 v244, v244, v100
  v_add_f32 v245, v245, v101
  v_add_f32 v246, v246, v102
  v_add_f32 v247, v247, v103
  s_mov_b32 s62, 8192
  buffer_store_dwordx4 v[244:247], v214, s[40:43], s62 offen sc1
  s_waitcnt lgkmcnt(1)
  v_add_f32 v248, v248, v104
  v_add_f32 v249, v249, v105
  v_add_f32 v250, v250, v106
  v_add_f32 v251, v251, v107
  s_mov_b32 s62, 16384
  buffer_store_dwordx4 v[248:251], v214, s[40:43], s62 offen sc1
  s_waitcnt lgkmcnt(0)
  v_add_f32 v252, v252, v108
  v_add_f32 v253, v253, v109
  v_add_f32 v254, v254, v110
  v_add_f32 v255, v255, v111
  s_mov_b32 s62, 24576
  buffer_store_dwordx4 v[252:255], v214, s[40:43], s62 offen sc1
END:
  s_endpgm

.section .rodata,"a"
.p2align 6
.amdhsa_kernel gated_mix__ssm_conv_s5__glu_gated_swiglu__prompt_kernel
  .amdhsa_next_free_vgpr 512
  .amdhsa_next_free_sgpr 102
  .amdhsa_accum_offset 256
  .amdhsa_group_segment_fixed_size 0
  .amdhsa_kernarg_size 136
  .amdhsa_user_sgpr_count 2
  .amdhsa_user_sgpr_kernarg_segment_ptr 1
  .amdhsa_system_sgpr_workgroup_id_x 1
.end_amdhsa_kernel
```
